```python
import torch

def _softmax(x, axis=-1):
    return torch.softmax(x, dim=axis)

def _gelu(x):
    return torch.nn.functional.gelu(x, approximate='tanh')

def _silu(x):
    return torch.nn.functional.silu(x)

def _sigmoid(x):
    return torch.sigmoid(x)

def _layernorm(x, axis=-1, eps=1e-05):
    m = x.mean(dim=axis, keepdim=True)
    v = x.var(dim=axis, keepdim=True, unbiased=False)
    return (x - m) / torch.sqrt(v + eps)

def _scatter_add(tgt, idx, src, axis=0):
    return tgt.clone().index_add_(axis, idx, src)

def _segment_sum(src, seg, n):
    out = torch.zeros((n,) + src.shape[1:], dtype=src.dtype)
    return out.index_add_(0, seg, src)

def _pad(x, pw):
    flat = tuple((v for pair in reversed(pw) for v in pair))
    return torch.nn.functional.pad(x, flat)
kernel_name = 'standalone__kv_cache_quant_pre_rope_vs_post_rope__prompt'

def setup_inputs():

    _w = lambda a: (lambda t: t.to(torch.bfloat16) if t.is_floating_point() else t)(torch.as_tensor(a))
    B, Sq, Skv = (1, 2048, 2048)
    H, Dh0 = (8, 128)
    G = 64 if 64 > 0 else Dh0
    G = max(2, G // 2 * 2)
    Dh = max(G, Dh0 // G * G)
    Skv = max(Skv, Sq)
    ng = Dh // G
    bits = 3 if 3 > 1 else 4
    bits = max(2, min(8, bits))
    qmax = (1 << bits) - 1
    half = Dh // 2
    inv = 1.0 / 10000.0 ** (torch.arange(half) / max(1, half))
    ang_k = torch.arange(Skv)[:, None] * inv[None, :]
    ang_q = torch.arange(Skv - Sq, Skv)[:, None] * inv[None, :]
    kc = torch.cat([torch.cos(ang_k), torch.cos(ang_k)], dim=-1)
    ks = torch.cat([torch.sin(ang_k), torch.sin(ang_k)], dim=-1)
    qc = torch.cat([torch.cos(ang_q), torch.cos(ang_q)], dim=-1)
    qs = torch.cat([torch.sin(ang_q), torch.sin(ang_q)], dim=-1)
    qk_i = torch.randint(0, qmax + 1, (B, H, Skv, Dh)).to(torch.int32)
    qv_i = torch.randint(0, qmax + 1, (B, H, Skv, Dh)).to(torch.int32)
    ksc = torch.abs((lambda *s: torch.randn(*s, dtype=torch.bfloat16) * 0.4)(B, H, Skv, ng)) * 0.1 + 0.01
    kzp = torch.full((B, H, Skv, ng), qmax / 2.0)
    vsc = torch.abs((lambda *s: torch.randn(*s, dtype=torch.bfloat16) * 0.4)(B, H, Skv, ng)) * 0.1 + 0.01
    vzp = torch.full((B, H, Skv, ng), qmax / 2.0)
    return {'q': _w((lambda *s: torch.randn(*s, dtype=torch.bfloat16) * 6.4)(B, H, Sq, Dh) * 0.5), 'qk': _w(qk_i), 'k_scales': _w(ksc), 'k_zeros': _w(kzp), 'qv': _w(qv_i), 'v_scales': _w(vsc), 'v_zeros': _w(vzp), 'q_cos': _w(qc), 'q_sin': _w(qs), 'k_cos': _w(kc), 'k_sin': _w(ks)}

def reference(q, qk, k_scales, k_zeros, qv, v_scales, v_zeros, q_cos, q_sin, k_cos, k_sin):
    B, H, Sq, Dh = q.shape
    ng = k_scales.shape[-1]
    G = Dh // ng
    half = Dh // 2
    ks = (lambda x, n, axis: torch.repeat_interleave(x, n, dim=axis))(k_scales, G, axis=-1)
    kz = (lambda x, n, axis: torch.repeat_interleave(x, n, dim=axis))(k_zeros, G, axis=-1)
    k = ((lambda x, dt: x.to(dt))(qk, q.dtype) - kz) * ks
    vs = (lambda x, n, axis: torch.repeat_interleave(x, n, dim=axis))(v_scales, G, axis=-1)
    vz = (lambda x, n, axis: torch.repeat_interleave(x, n, dim=axis))(v_zeros, G, axis=-1)
    v = ((lambda x, dt: x.to(dt))(qv, q.dtype) - vz) * vs
    k1 = k[..., :half].clone()
    k2 = k[..., half:].clone()
    krh = torch.concatenate([-k2, k1], axis=-1)
    kr = k * k_cos[None, None, :, :] + krh * k_sin[None, None, :, :]
    q1 = q[..., :half].clone()
    q2 = q[..., half:].clone()
    qrh = torch.concatenate([-q2, q1], axis=-1)
    qr = q * q_cos[None, None, :, :] + qrh * q_sin[None, None, :, :]
    logits = torch.einsum('bhqd,bhkd->bhqk', qr, kr) * float(Dh) ** (-0.5)
    attn = _softmax(logits, axis=-1)
    out = torch.einsum('bhqk,bhkd->bhqd', attn, v)
    return out
```

```asm
; @launch grid=(256,1,1) block=(256,1,1) lds=140288
.amdgcn_target "amdgcn-amd-amdhsa--gfx950"
.text
.globl standalone__kv_cache_quant_pre_rope_vs_post_rope__prompt_kernel
.p2align 8
.type standalone__kv_cache_quant_pre_rope_vs_post_rope__prompt_kernel,@function
standalone__kv_cache_quant_pre_rope_vs_post_rope__prompt_kernel:
    s_cmp_ge_u32 s2, 256
    s_cbranch_scc1 L_done
    s_nop 0
    s_load_dwordx2 s[20:21], s[0:1], 8
    s_load_dwordx2 s[24:25], s[0:1], 16
    s_load_dwordx2 s[28:29], s[0:1], 24
    s_load_dwordx2 s[52:53], s[0:1], 72
    s_load_dwordx2 s[56:57], s[0:1], 80
    s_load_dwordx2 s[32:33], s[0:1], 32
    s_load_dwordx2 s[36:37], s[0:1], 40
    s_load_dwordx2 s[40:41], s[0:1], 48
    s_load_dwordx2 s[16:17], s[0:1], 0
    s_load_dwordx2 s[44:45], s[0:1], 56
    s_load_dwordx2 s[48:49], s[0:1], 64
    s_load_dwordx2 s[4:5], s[0:1], 104
    s_load_dwordx2 s[6:7], s[0:1], 96
    s_load_dwordx2 s[14:15], s[0:1], 88
    v_lshrrev_b32 v1, 6, v0
    v_and_b32 v0, 63, v0
    v_readfirstlane_b32 s8, v1
    s_and_b32 s9, s2, 7
    s_lshr_b32 s10, s2, 3
    v_lshrrev_b32 v5, 4, v0
    v_and_b32 v6, 15, v0
    v_lshlrev_b32 v8, 8, v5
    v_lshl_add_u32 v8, v6, 3, v8
    v_and_b32 v9, 1, v6
    v_lshlrev_b32 v9, 13, v9
    v_lshl_add_u32 v9, v5, 2, v9
    v_lshlrev_b32_e64 v10, 9, v5
    v_lshl_add_u32 v10, v6, 4, v10
    v_lshlrev_b32_e64 v11, 8, v6
    v_lshl_add_u32 v11, v5, 4, v11
    v_lshlrev_b32_e64 v12, 11, v5
    v_lshl_add_u32 v12, v6, 3, v12
    v_lshlrev_b32 v13, 4, v5
    v_lshlrev_b32 v2, 4, v0
    v_mov_b32 v15, 0xffff0000
    v_lshrrev_b32 v3, 3, v0
    v_and_b32 v4, 7, v0
    v_lshlrev_b32_e64 v14, 8, v3
    v_lshl_add_u32 v14, v4, 4, v14
    v_mov_b32 v16, 2048
    v_mov_b32_e64 v17, 0
    ds_write_b32 v16, v17
    s_waitcnt lgkmcnt(0)
    s_nop 0
    s_and_b32 s21, s21, 0xffff
    s_mov_b32 s22, 8388608
    s_mov_b32 s23, 0x00020000
    s_and_b32 s25, s25, 0xffff
    s_mov_b32 s26, 65536
    s_mov_b32 s27, 0x00020000
    s_and_b32 s29, s29, 0xffff
    s_mov_b32 s30, 65536
    s_mov_b32 s31, 0x00020000
    s_and_b32 s53, s53, 0xffff
    s_mov_b32 s54, 524288
    s_mov_b32 s55, 0x00020000
    s_and_b32 s57, s57, 0xffff
    s_mov_b32 s58, 524288
    s_mov_b32 s59, 0x00020000
    s_and_b32 s33, s33, 0xffff
    s_mov_b32 s34, 8388608
    s_mov_b32 s35, 0x00020000
    s_and_b32 s37, s37, 0xffff
    s_mov_b32 s38, 65536
    s_mov_b32 s39, 0x00020000
    s_and_b32 s41, s41, 0xffff
    s_mov_b32 s42, 65536
    s_mov_b32 s43, 0x00020000
    s_cmp_lg_u32 s2, 0
    s_cbranch_scc1 L_noinit
    s_cmp_lg_u32 s8, 0
    s_cbranch_scc1 L_noinit
    s_add_u32 s98, s4, 12582912
    s_addc_u32 s99, s5, 0
    v_lshlrev_b32 v16, 7, v0
    v_mov_b32_e64 v17, 0
    s_mov_b64 exec, 0xffffffff
    global_store_dword v16, v17, s[98:99] sc1
    s_waitcnt vmcnt(0)
    v_mov_b32 v17, 1
    v_mov_b32 v16, 0
    s_mov_b64 exec, 1
    global_store_dword v16, v17, s[6:7] sc1
    s_mov_b64 exec, -1
L_noinit:
    s_lshl_b32 s100, s2, 2
    s_lshl_b32 s98, s8, 14
    s_lshl_b32 s99, s100, 2
    s_add_u32 s98, s98, s99
    s_nop 0
    buffer_load_dword v24, v9, s[24:27], s98 offen
    buffer_load_dword v25, v9, s[28:31], s98 offen
    s_lshl_b32 s99, s100, 8
    s_nop 0
    buffer_load_dwordx2 v[28:29], v8, s[52:55], s99 offen
    buffer_load_dwordx2 v[30:31], v8, s[52:55], s99 offen offset:128
    buffer_load_dwordx2 v[32:33], v8, s[56:59], s99 offen
    buffer_load_dwordx2 v[34:35], v8, s[56:59], s99 offen offset:128
    s_lshl_b32 s98, s8, 21
    s_lshl_b32 s99, s100, 9
    s_add_u32 s98, s98, s99
    s_nop 0
    s_add_u32 s99, s98, 0x100000
    buffer_load_dwordx4 v[36:39], v10, s[20:23], s98 offen nt
    buffer_load_dwordx4 v[40:43], v10, s[20:23], s98 offen offset:256 nt
    buffer_load_dwordx4 v[44:47], v10, s[20:23], s99 offen nt
    buffer_load_dwordx4 v[48:51], v10, s[20:23], s99 offen offset:256 nt
    s_lshl_b32 s100, s10, 5
    s_lshl_b32 s98, s9, 13
    s_lshl_b32 s99, s100, 2
    s_add_u32 s98, s98, s99
    buffer_load_dwordx4 v[96:99], v13, s[36:39], s98 offen offset:0
    buffer_load_dwordx4 v[104:107], v13, s[40:43], s98 offen offset:0
    buffer_load_dwordx4 v[100:103], v13, s[36:39], s98 offen offset:64
    buffer_load_dwordx4 v[108:111], v13, s[40:43], s98 offen offset:64
    s_lshl_b32 s98, s9, 20
    s_lshl_b32 s99, s100, 9
    s_add_u32 s98, s98, s99
    s_lshl_b32 s99, s8, 7
    s_add_u32 s98, s98, s99
    s_nop 0
    s_add_u32 s99, s98, 8192
    buffer_load_dwordx2 v[80:81], v12, s[32:35], s98 offen offset:0 nt
    buffer_load_dwordx2 v[82:83], v12, s[32:35], s98 offen offset:512 nt
    buffer_load_dwordx2 v[84:85], v12, s[32:35], s98 offen offset:1024 nt
    buffer_load_dwordx2 v[86:87], v12, s[32:35], s98 offen offset:1536 nt
    buffer_load_dwordx2 v[88:89], v12, s[32:35], s99 offen offset:0 nt
    buffer_load_dwordx2 v[90:91], v12, s[32:35], s99 offen offset:512 nt
    buffer_load_dwordx2 v[92:93], v12, s[32:35], s99 offen offset:1024 nt
    buffer_load_dwordx2 v[94:95], v12, s[32:35], s99 offen offset:1536 nt
    s_and_b32 s17, s17, 0xffff
    s_mov_b32 s18, 4194304
    s_mov_b32 s19, 0x00020000
    s_and_b32 s45, s45, 0xffff
    s_mov_b32 s46, 524288
    s_mov_b32 s47, 0x00020000
    s_and_b32 s49, s49, 0xffff
    s_mov_b32 s50, 524288
    s_mov_b32 s51, 0x00020000
    s_mov_b32 s60, s4
    s_mov_b32 s61, s5
    s_and_b32 s61, s61, 0xffff
    s_mov_b32 s62, 268435456
    s_mov_b32 s63, 0x00020000
    s_mov_b32 s98, 0xbe549a78
    s_mov_b32 s99, 0x3e22f983
    v_lshlrev_b32 v16, 3, v4
    v_add_u32 v244, 0, v16
    v_add_u32 v245, 1, v16
    v_add_u32 v246, 2, v16
    v_add_u32 v247, 3, v16
    v_add_u32 v248, 4, v16
    v_add_u32 v249, 5, v16
    v_add_u32 v250, 6, v16
    v_add_u32 v251, 7, v16
    v_cvt_f32_u32 v244, v244
    v_cvt_f32_u32 v245, v245
    v_cvt_f32_u32 v246, v246
    v_cvt_f32_u32 v247, v247
    v_cvt_f32_u32 v248, v248
    v_cvt_f32_u32 v249, v249
    v_cvt_f32_u32 v250, v250
    v_cvt_f32_u32 v251, v251
    v_mul_f32 v244, s98, v244
    v_mul_f32 v245, s98, v245
    v_mul_f32 v246, s98, v246
    v_mul_f32 v247, s98, v247
    v_mul_f32 v248, s98, v248
    v_mul_f32 v249, s98, v249
    v_mul_f32 v250, s98, v250
    v_mul_f32 v251, s98, v251
    v_exp_f32 v244, v244
    v_exp_f32 v245, v245
    v_exp_f32 v246, v246
    v_exp_f32 v247, v247
    v_exp_f32 v248, v248
    v_exp_f32 v249, v249
    v_exp_f32 v250, v250
    v_exp_f32 v251, v251
    s_nop 0
    v_mul_f32 v244, s99, v244
    v_mul_f32 v245, s99, v245
    v_mul_f32 v246, s99, v246
    v_mul_f32 v247, s99, v247
    v_mul_f32 v248, s99, v248
    v_mul_f32 v249, s99, v249
    v_mul_f32 v250, s99, v250
    v_mul_f32 v251, s99, v251
    s_lshr_b32 s101, s2, 3
    s_lshl_b32 s101, s101, 14
    s_lshr_b32 s3, s2, 2
    s_and_b32 s3, s3, 1
    s_lshl_b32 s3, s3, 12
    s_add_u32 s101, s101, s3
    s_and_b32 s3, s2, 3
    s_lshl_b32 s3, s3, 6
    s_add_u32 s101, s101, s3
    s_lshl_b32 s3, s8, 21
    s_add_u32 s101, s101, s3
    s_waitcnt vmcnt(16)
    v_lshlrev_b32 v52, 16, v28
    v_and_b32 v53, v15, v28
    v_lshlrev_b32 v54, 16, v29
    v_and_b32 v55, v15, v29
    v_lshlrev_b32 v56, 16, v30
    v_and_b32 v57, v15, v30
    v_lshlrev_b32 v58, 16, v31
    v_and_b32 v59, v15, v31
    v_lshlrev_b32 v60, 16, v32
    v_and_b32 v61, v15, v32
    v_lshlrev_b32 v62, 16, v33
    v_and_b32 v63, v15, v33
    v_lshlrev_b32 v64, 16, v34
    v_and_b32 v65, v15, v34
    v_lshlrev_b32 v66, 16, v35
    v_and_b32_e64 v67, v15, v35
    v_mov_b32_dpp v68, v24 row_newbcast:0 row_mask:0xf bank_mask:0xf
    v_mov_b32_dpp v69, v25 row_newbcast:0 row_mask:0xf bank_mask:0xf
    s_waitcnt vmcnt(14)
    v_lshlrev_b32 v70, 16, v68
    v_and_b32 v71, v15, v68
    v_lshlrev_b32 v72, 16, v69
    v_and_b32 v73, v15, v69
    v_mul_f32 v72, v72, v70
    v_mul_f32 v73, v73, v71
    v_cvt_f32_i32 v36, v36
    v_cvt_f32_i32 v37, v37
    v_cvt_f32_i32 v38, v38
    v_cvt_f32_i32 v39, v39
    v_cvt_f32_i32 v40, v40
    v_cvt_f32_i32 v41, v41
    v_cvt_f32_i32 v42, v42
    v_cvt_f32_i32_e64 v43, v43
    v_fma_f32 v36, v36, v70, -v72
    v_fma_f32 v40, v40, v71, -v73
    v_fma_f32 v37, v37, v70, -v72
    v_fma_f32 v41, v41, v71, -v73
    v_fma_f32 v38, v38, v70, -v72
    v_fma_f32 v42, v42, v71, -v73
    v_fma_f32 v39, v39, v70, -v72
    v_fma_f32 v43, v43, v71, -v73
    v_mul_f32 v68, v40, v60
    v_mul_f32 v69, v36, v64
    v_fma_f32 v36, v36, v52, -v68
    v_fma_f32 v40, v40, v56, v69
    v_mul_f32 v68, v41, v61
    v_mul_f32 v69, v37, v65
    v_fma_f32 v37, v37, v53, -v68
    v_fma_f32 v41, v41, v57, v69
    v_mul_f32 v68, v42, v62
    v_mul_f32 v69, v38, v66
    v_fma_f32 v38, v38, v54, -v68
    v_fma_f32 v42, v42, v58, v69
    v_mul_f32 v68, v43, v63
    v_mul_f32 v69, v39, v67
    v_fma_f32 v39, v39, v55, -v68
    v_fma_f32 v43, v43, v59, v69
    v_cvt_pk_bf16_f32 v36, v36, v37
    v_cvt_pk_bf16_f32 v37, v38, v39
    v_cvt_pk_bf16_f32 v38, v40, v41
    v_cvt_pk_bf16_f32 v39, v42, v43
    buffer_store_dwordx4 v[36:39], v11, s[60:63], s101 offen sc1
    s_add_u32 s101, s101, 0x100000
    v_mov_b32_dpp v68, v24 row_newbcast:1 row_mask:0xf bank_mask:0xf
    v_mov_b32_dpp v69, v25 row_newbcast:1 row_mask:0xf bank_mask:0xf
    s_waitcnt vmcnt(13)
    v_lshlrev_b32 v70, 16, v68
    v_and_b32 v71, v15, v68
    v_lshlrev_b32 v72, 16, v69
    v_and_b32 v73, v15, v69
    v_mul_f32 v72, v72, v70
    v_mul_f32 v73, v73, v71
    v_cvt_f32_i32 v44, v44
    v_cvt_f32_i32 v45, v45
    v_cvt_f32_i32 v46, v46
    v_cvt_f32_i32 v47, v47
    v_cvt_f32_i32 v48, v48
    v_cvt_f32_i32 v49, v49
    v_cvt_f32_i32 v50, v50
    v_cvt_f32_i32_e64 v51, v51
    v_fma_f32 v44, v44, v70, -v72
    v_fma_f32 v48, v48, v71, -v73
    v_fma_f32 v45, v45, v70, -v72
    v_fma_f32 v49, v49, v71, -v73
    v_fma_f32 v46, v46, v70, -v72
    v_fma_f32 v50, v50, v71, -v73
    v_fma_f32 v47, v47, v70, -v72
    v_fma_f32 v51, v51, v71, -v73
    v_mul_f32 v68, v48, v60
    v_mul_f32 v69, v44, v64
    v_fma_f32 v44, v44, v52, -v68
    v_fma_f32 v48, v48, v56, v69
    v_mul_f32 v68, v49, v61
    v_mul_f32 v69, v45, v65
    v_fma_f32 v45, v45, v53, -v68
    v_fma_f32 v49, v49, v57, v69
    v_mul_f32 v68, v50, v62
    v_mul_f32 v69, v46, v66
    v_fma_f32 v46, v46, v54, -v68
    v_fma_f32 v50, v50, v58, v69
    v_mul_f32 v68, v51, v63
    v_mul_f32 v69, v47, v67
    v_fma_f32 v47, v47, v55, -v68
    v_fma_f32 v51, v51, v59, v69
    v_cvt_pk_bf16_f32 v44, v44, v45
    v_cvt_pk_bf16_f32 v45, v46, v47
    v_cvt_pk_bf16_f32 v46, v48, v49
    v_cvt_pk_bf16_f32 v47, v50, v51
    buffer_store_dwordx4 v[44:47], v11, s[60:63], s101 offen sc1
    s_lshr_b32 s3, s8, 1
    s_lshl_b32 s3, s3, 4
    s_sub_u32 s3, 16, s3
    s_waitcnt vmcnt(10)
    v_lshlrev_b32 v96, s3, v96
    v_lshlrev_b32 v104, s3, v104
    v_and_b32 v96, v15, v96
    v_and_b32 v104, v15, v104
    v_mul_f32 v104, v104, v96
    v_lshlrev_b32 v97, s3, v97
    v_lshlrev_b32 v105, s3, v105
    v_and_b32 v97, v15, v97
    v_and_b32 v105, v15, v105
    v_mul_f32 v105, v105, v97
    v_lshlrev_b32 v98, s3, v98
    v_lshlrev_b32 v106, s3, v106
    v_and_b32 v98, v15, v98
    v_and_b32 v106, v15, v106
    v_mul_f32 v106, v106, v98
    v_lshlrev_b32 v99, s3, v99
    v_lshlrev_b32 v107, s3, v107
    v_and_b32 v99, v15, v99
    v_and_b32 v107, v15, v107
    v_mul_f32 v107, v107, v99
    v_lshlrev_b32 v100, s3, v100
    v_lshlrev_b32 v108, s3, v108
    v_and_b32 v100, v15, v100
    v_and_b32 v108, v15, v108
    v_mul_f32 v108, v108, v100
    v_lshlrev_b32 v101, s3, v101
    v_lshlrev_b32 v109, s3, v109
    v_and_b32 v101, v15, v101
    v_and_b32 v109, v15, v109
    v_mul_f32 v109, v109, v101
    v_lshlrev_b32 v102, s3, v102
    v_lshlrev_b32 v110, s3, v110
    v_and_b32 v102, v15, v102
    v_and_b32 v110, v15, v110
    v_mul_f32 v110, v110, v102
    v_lshlrev_b32 v103, s3, v103
    v_lshlrev_b32 v111, s3, v111
    v_and_b32 v103, v15, v103
    v_and_b32 v111, v15, v111
    v_mul_f32 v111, v111, v103
    s_waitcnt vmcnt(2)
    v_cvt_f32_i32 v80, v80
    v_cvt_f32_i32 v81, v81
    v_cvt_f32_i32 v82, v82
    v_cvt_f32_i32 v83, v83
    v_cvt_f32_i32 v84, v84
    v_cvt_f32_i32 v85, v85
    v_cvt_f32_i32 v86, v86
    v_cvt_f32_i32 v87, v87
    v_cvt_f32_i32 v88, v88
    v_cvt_f32_i32 v89, v89
    v_cvt_f32_i32 v90, v90
    v_cvt_f32_i32 v91, v91
    v_cvt_f32_i32 v92, v92
    v_cvt_f32_i32 v93, v93
    v_cvt_f32_i32 v94, v94
    v_cvt_f32_i32_e64 v95, v95
    v_fma_f32 v80, v80, v96, -v104
    v_fma_f32 v81, v81, v96, -v104
    v_fma_f32 v82, v82, v97, -v105
    v_fma_f32 v83, v83, v97, -v105
    v_fma_f32 v84, v84, v98, -v106
    v_fma_f32 v85, v85, v98, -v106
    v_fma_f32 v86, v86, v99, -v107
    v_fma_f32 v87, v87, v99, -v107
    v_fma_f32 v88, v88, v100, -v108
    v_fma_f32 v89, v89, v100, -v108
    v_fma_f32 v90, v90, v101, -v109
    v_fma_f32 v91, v91, v101, -v109
    v_fma_f32 v92, v92, v102, -v110
    v_fma_f32 v93, v93, v102, -v110
    v_fma_f32 v94, v94, v103, -v111
    v_fma_f32 v95, v95, v103, -v111
    s_lshl_b32 s98, s9, 20
    s_lshl_b32 s99, s10, 14
    s_add_u32 s98, s98, s99
    s_lshl_b32 s99, s8, 11
    s_add_u32 s98, s98, s99
    s_nop 0
    s_add_u32 s98, s98, 8192
    v_cvt_pk_bf16_f32 v96, v80, v82
    v_cvt_pk_bf16_f32 v97, v84, v86
    v_cvt_pk_bf16_f32 v98, v88, v90
    v_cvt_pk_bf16_f32 v99, v92, v94
    buffer_store_dwordx4 v[96:99], v2, s[60:63], s98 offen offset:0 sc1
    v_cvt_pk_bf16_f32 v100, v81, v83
    v_cvt_pk_bf16_f32 v101, v85, v87
    v_cvt_pk_bf16_f32 v102, v89, v91
    v_cvt_pk_bf16_f32 v103, v93, v95
    buffer_store_dwordx4 v[100:103], v2, s[60:63], s98 offen offset:1024 sc1
    v_mov_b32_e64 v16, 0
    global_load_dword v17, v16, s[6:7] sc1
    s_lshl_b32 s98, s10, 6
    s_lshl_b32 s99, s8, 4
    s_add_u32 s98, s98, s99
    s_lshl_b32 s99, s98, 8
    s_lshl_b32 s98, s9, 19
    s_add_u32 s98, s98, s99
    buffer_load_dwordx4 v[140:143], v14, s[16:19], s98 offen offset:0 nt
    buffer_load_dwordx4 v[144:147], v14, s[16:19], s98 offen offset:128 nt
    buffer_load_dwordx4 v[164:167], v14, s[16:19], s98 offen offset:2048 nt
    buffer_load_dwordx4 v[168:171], v14, s[16:19], s98 offen offset:2176 nt
    s_mov_b32 exec_lo, 0
    s_nop 0
    s_mov_b32 exec_hi, 0xff000000
    buffer_load_dwordx4 v[252:255], v14, s[44:47], s99 offen
    buffer_load_dwordx4 v[76:79], v14, s[48:51], s99 offen offset:128
    s_mov_b64 exec, -1
    s_lshl_b32 s98, s10, 6
    s_lshl_b32 s99, s8, 4
    s_add_u32 s98, s98, s99
    v_add_u32 v188, s98, v3
    v_cvt_f32_u32 v188, v188
    v_mul_f32 v60, v188, v244
    v_mul_f32 v61, v188, v245
    v_mul_f32 v62, v188, v246
    v_mul_f32 v63, v188, v247
    v_mul_f32 v64, v188, v248
    v_mul_f32 v65, v188, v249
    v_mul_f32 v66, v188, v250
    v_mul_f32 v67, v188, v251
    v_fract_f32 v60, v60
    v_fract_f32 v61, v61
    v_fract_f32 v62, v62
    v_fract_f32 v63, v63
    v_fract_f32 v64, v64
    v_fract_f32 v65, v65
    v_fract_f32 v66, v66
    v_fract_f32 v67, v67
    v_cos_f32 v52, v60
    v_cos_f32 v53, v61
    v_cos_f32 v54, v62
    v_cos_f32 v55, v63
    v_cos_f32 v56, v64
    v_cos_f32 v57, v65
    v_cos_f32 v58, v66
    v_cos_f32 v59, v67
    v_sin_f32 v60, v60
    v_sin_f32 v61, v61
    v_sin_f32 v62, v62
    v_sin_f32 v63, v63
    v_sin_f32 v64, v64
    v_sin_f32 v65, v65
    v_sin_f32 v66, v66
    v_sin_f32 v67, v67
    s_nop 0
    s_nop 0
    v_cvt_pk_bf16_f32 v189, v52, v53
    v_cvt_pk_bf16_f32 v190, v54, v55
    v_cvt_pk_bf16_f32 v191, v56, v57
    v_cvt_pk_bf16_f32 v192, v58, v59
    v_lshlrev_b32 v52, 16, v189
    v_and_b32 v53, v15, v189
    v_lshlrev_b32 v54, 16, v190
    v_and_b32 v55, v15, v190
    v_lshlrev_b32 v56, 16, v191
    v_and_b32 v57, v15, v191
    v_lshlrev_b32 v58, 16, v192
    v_and_b32 v59, v15, v192
    v_cvt_pk_bf16_f32 v189, v60, v61
    v_cvt_pk_bf16_f32 v190, v62, v63
    v_cvt_pk_bf16_f32 v191, v64, v65
    v_cvt_pk_bf16_f32 v192, v66, v67
    v_lshlrev_b32 v60, 16, v189
    v_and_b32 v61, v15, v189
    v_lshlrev_b32 v62, 16, v190
    v_and_b32 v63, v15, v190
    v_lshlrev_b32 v64, 16, v191
    v_and_b32 v65, v15, v191
    v_lshlrev_b32 v66, 16, v192
    v_and_b32 v67, v15, v192
    s_waitcnt vmcnt(6)
    s_barrier
    s_cmp_lg_u32 s8, 0
    s_cbranch_scc1 L_noflag
    s_add_u32 s100, s4, 12582912
    s_addc_u32 s101, s5, 0
    s_mov_b32 s99, 0
L_rdy:
    v_readfirstlane_b32 s98, v17
    s_add_u32 s99, s99, 1
    s_cmp_lg_u32 s98, 0
    s_cbranch_scc1 L_rdy_ok
    global_load_dword v17, v16, s[6:7] sc1
    s_waitcnt vmcnt(0)
    s_nop 0
    s_cmp_lt_u32 s99, 0x40000
    s_cbranch_scc1 L_rdy
L_rdy_ok:
    s_lshr_b32 s98, s2, 3
    s_lshl_b32 s98, s98, 7
    v_mov_b32 v16, s98
    v_mov_b32 v17, 1
    s_mov_b64 exec, 1
    global_atomic_add v16, v17, s[100:101] sc1
    s_mov_b64 exec, -1
L_noflag:
    s_waitcnt vmcnt(0)
    v_mov_b32 v188, 0
    v_lshlrev_b32 v189, 16, v252
    v_and_b32 v190, v15, v252
    v_sub_f32 v189, v189, v52
    v_sub_f32_e64 v190, v190, v53
    v_max3_f32 v188, v188, |v189|, |v190|
    v_add_f32 v191, v189, v190
    v_lshlrev_b32 v189, 16, v253
    v_and_b32 v190, v15, v253
    v_sub_f32 v189, v189, v54
    v_sub_f32_e64 v190, v190, v55
    v_max3_f32 v188, v188, |v189|, |v190|
    v_add_f32 v191, v191, v189
    v_lshlrev_b32 v189, 16, v254
    v_and_b32 v190, v15, v254
    v_sub_f32 v189, v189, v56
    v_sub_f32_e64 v190, v190, v57
    v_max3_f32 v188, v188, |v189|, |v190|
    s_lshl_b32 s13, s2, 2
    s_nop 0
    s_add_u32 s13, s13, 1024
    s_lshl_b32 s11, s8, 14
    s_lshl_b32 s12, s13, 2
    s_add_u32 s11, s11, s12
    s_nop 0
    buffer_load_dword v112, v9, s[24:27], s11 offen
    v_add_f32 v191, v191, v189
    v_lshlrev_b32 v189, 16, v255
    v_and_b32 v190, v15, v255
    v_sub_f32 v189, v189, v58
    v_sub_f32_e64 v190, v190, v59
    v_max3_f32 v188, v188, |v189|, |v190|
    v_add_f32 v191, v191, v189
    v_lshlrev_b32 v189, 16, v76
    v_and_b32 v190, v15, v76
    v_sub_f32 v189, v189, v60
    v_sub_f32_e64 v190, v190, v61
    v_max3_f32 v188, v188, |v189|, |v190|
    v_add_f32 v191, v191, v189
    v_lshlrev_b32 v189, 16, v77
    v_and_b32 v190, v15, v77
    v_sub_f32 v189, v189, v62
    v_sub_f32_e64 v190, v190, v63
    v_max3_f32 v188, v188, |v189|, |v190|
    v_add_f32_e64 v191, v191, v189
    buffer_load_dword v113, v9, s[28:31], s11 offen
    v_lshlrev_b32 v189, 16, v78
    v_and_b32 v190, v15, v78
    v_sub_f32 v189, v189, v64
    v_sub_f32 v190, v190, v65
    v_max3_f32 v188, v188, |v189|, |v190|
    v_add_f32 v191, v191, v189
    v_lshlrev_b32 v189, 16, v79
    v_and_b32 v190, v15, v79
    v_sub_f32 v189, v189, v66
    v_sub_f32_e64 v190, v190, v67
    v_max3_f32 v188, v188, |v189|, |v190|
    v_add_f32_e64 v191, v191, v189
    s_mov_b32 s98, 0x3c000000
    v_cmp_ge_f32 vcc, s98, v188
    s_nop 0
    v_cmp_o_f32 s[98:99], v191, v191
    s_and_b64 vcc, vcc, s[98:99]
    s_lshr_b32 s98, vcc_hi, 24
    s_cmp_lg_u32 s98, 0xff
    s_cselect_b32 s96, 1, 0
    s_lshl_b32 s12, s13, 8
    buffer_load_dwordx2 v[114:115], v8, s[52:55], s12 offen
    s_cmp_lg_u32 s96, 0
    s_cbranch_scc1 L_qfb0
    v_lshlrev_b32 v208, 1, v4
    v_add_u32 v209, v208, v3
    v_and_b32 v209, 15, v209
    v_lshlrev_b32 v209, 4, v209
    v_lshl_add_u32 v210, v208, 8, v209
    v_lshlrev_b32 v208, 1, v4
    v_add_u32 v208, 1, v208
    v_add_u32 v209, v208, v3
    v_and_b32 v209, 15, v209
    v_lshlrev_b32_e64 v209, 4, v209
    v_lshl_add_u32 v211, v208, 8, v209
    s_lshl_b32 s98, s8, 12
    s_nop 0
    s_add_u32 s98, s98, 9216
    v_add_u32 v210, s98, v210
    v_add_u32 v211, s98, v211
    s_mov_b32 s3, 0x3e0293ee
    s_waitcnt vmcnt(7)
    v_lshlrev_b32 v188, 16, v140
    v_lshlrev_b32 v196, 16, v144
    v_and_b32 v189, v15, v140
    v_and_b32 v197, v15, v144
    v_lshlrev_b32 v190, 16, v141
    v_lshlrev_b32 v198, 16, v145
    v_and_b32 v191, v15, v141
    v_and_b32 v199, v15, v145
    v_lshlrev_b32 v192, 16, v142
    v_lshlrev_b32_e64 v200, 16, v146
    buffer_load_dwordx2 v[116:117], v8, s[52:55], s12 offen offset:128
    v_and_b32 v193, v15, v142
    v_and_b32 v201, v15, v146
    v_lshlrev_b32 v194, 16, v143
    v_lshlrev_b32 v202, 16, v147
    v_and_b32 v195, v15, v143
    v_and_b32 v203, v15, v147
    v_mul_f32 v206, v196, v60
    v_mul_f32 v207, v188, v60
    v_fma_f32 v188, v188, v52, -v206
    v_fma_f32 v196, v196, v52, v207
    v_mul_f32_e64 v188, s3, v188
    buffer_load_dwordx2 v[118:119], v8, s[56:59], s12 offen
    v_mul_f32 v196, s3, v196
    v_mul_f32 v206, v197, v61
    v_mul_f32_e64 v207, v189, v61
    v_fma_f32 v189, v189, v53, -v206
    v_fma_f32 v197, v197, v53, v207
    v_mul_f32 v189, s3, v189
    v_mul_f32 v197, s3, v197
    v_mul_f32 v206, v198, v62
    v_mul_f32 v207, v190, v62
    v_fma_f32 v190, v190, v54, -v206
    v_fma_f32 v198, v198, v54, v207
    buffer_load_dwordx2 v[120:121], v8, s[56:59], s12 offen offset:128
    v_mul_f32 v190, s3, v190
    v_mul_f32 v198, s3, v198
    v_mul_f32 v206, v199, v63
    v_mul_f32 v207, v191, v63
    v_fma_f32 v191, v191, v55, -v206
    v_fma_f32 v199, v199, v55, v207
    v_mul_f32 v191, s3, v191
    v_mul_f32 v199, s3, v199
    v_mul_f32 v206, v200, v64
    v_mul_f32 v207, v192, v64
    s_lshl_b32 s11, s8, 21
    s_lshl_b32 s12, s13, 9
    s_add_u32 s11, s11, s12
    s_nop 0
    s_add_u32 s12, s11, 0x100000
    buffer_load_dwordx4 v[122:125], v10, s[20:23], s11 offen nt
    v_fma_f32 v192, v192, v56, -v206
    v_fma_f32 v200, v200, v56, v207
    v_mul_f32 v192, s3, v192
    v_mul_f32 v200, s3, v200
    v_mul_f32 v206, v201, v65
    v_mul_f32 v207, v193, v65
    v_fma_f32 v193, v193, v57, -v206
    v_fma_f32 v201, v201, v57, v207
    v_mul_f32 v193, s3, v193
    v_mul_f32 v201, s3, v201
    v_mul_f32_e64 v206, v202, v66
    buffer_load_dwordx4 v[126:129], v10, s[20:23], s11 offen offset:256 nt
    v_mul_f32_e64 v207, v194, v66
    v_fma_f32 v194, v194, v58, -v206
    v_fma_f32 v202, v202, v58, v207
    v_mul_f32 v194, s3, v194
    v_mul_f32 v202, s3, v202
    v_mul_f32 v206, v203, v67
    v_mul_f32 v207, v195, v67
    v_fma_f32 v195, v195, v59, -v206
    v_fma_f32 v203, v203, v59, v207
    v_mul_f32 v195, s3, v195
    v_mul_f32 v203, s3, v203
    buffer_load_dwordx4 v[130:133], v10, s[20:23], s12 offen nt
    v_cvt_pk_bf16_f32 v140, v188, v189
    v_cvt_pk_bf16_f32 v141, v190, v191
    v_cvt_pk_bf16_f32 v142, v196, v197
    v_cvt_pk_bf16_f32 v143, v198, v199
    ds_write_b128 v210, v[140:143]
    v_cvt_pk_bf16_f32 v144, v192, v193
    v_cvt_pk_bf16_f32 v145, v194, v195
    v_cvt_pk_bf16_f32 v146, v200, v201
    v_cvt_pk_bf16_f32 v147, v202, v203
    ds_write_b128 v211, v[144:147]
    buffer_load_dwordx4 v[134:137], v10, s[20:23], s12 offen offset:256 nt
    s_branch L_qj0
L_qfb0:
    s_nop 0
    buffer_load_dwordx2 v[116:117], v8, s[52:55], s12 offen offset:128
    buffer_load_dwordx2 v[118:119], v8, s[56:59], s12 offen
    buffer_load_dwordx2 v[120:121], v8, s[56:59], s12 offen offset:128
    s_lshl_b32 s11, s8, 21
    s_lshl_b32 s12, s13, 9
    s_add_u32 s11, s11, s12
    s_nop 0
    s_add_u32 s12, s11, 0x100000
    buffer_load_dwordx4 v[122:125], v10, s[20:23], s11 offen nt
    buffer_load_dwordx4 v[126:129], v10, s[20:23], s11 offen offset:256 nt
    buffer_load_dwordx4 v[130:133], v10, s[20:23], s12 offen nt
    buffer_load_dwordx4 v[134:137], v10, s[20:23], s12 offen offset:256 nt
    s_lshl_b32 s98, s10, 6
    s_lshl_b32 s99, s8, 4
    s_add_u32 s98, s98, s99
    s_lshl_b32 s99, s98, 8
    buffer_load_dwordx4 v[148:151], v14, s[44:47], s99 offen offset:0
    buffer_load_dwordx4 v[152:155], v14, s[44:47], s99 offen offset:128
    buffer_load_dwordx4 v[156:159], v14, s[48:51], s99 offen offset:0
    buffer_load_dwordx4 v[160:163], v14, s[48:51], s99 offen offset:128
    s_waitcnt vmcnt(0)
    v_lshlrev_b32 v208, 1, v4
    v_add_u32 v209, v208, v3
    v_and_b32 v209, 15, v209
    v_lshlrev_b32_e64 v209, 4, v209
    v_lshl_add_u32 v210, v208, 8, v209
    v_lshlrev_b32 v208, 1, v4
    v_add_u32 v208, 1, v208
    v_add_u32 v209, v208, v3
    v_and_b32 v209, 15, v209
    v_lshlrev_b32_e64 v209, 4, v209
    v_lshl_add_u32 v211, v208, 8, v209
    s_lshl_b32 s98, s8, 12
    s_nop 0
    s_add_u32 s98, s98, 9216
    v_add_u32 v210, s98, v210
    v_add_u32 v211, s98, v211
    s_mov_b32 s3, 0x3e0293ee
    v_lshlrev_b32 v188, 16, v140
    v_lshlrev_b32 v196, 16, v144
    v_and_b32 v189, v15, v140
    v_and_b32 v197, v15, v144
    v_lshlrev_b32 v190, 16, v141
    v_lshlrev_b32 v198, 16, v145
    v_and_b32 v191, v15, v141
    v_and_b32 v199, v15, v145
    v_lshlrev_b32 v192, 16, v142
    v_lshlrev_b32 v200, 16, v146
    v_and_b32 v193, v15, v142
    v_and_b32 v201, v15, v146
    v_lshlrev_b32 v194, 16, v143
    v_lshlrev_b32 v202, 16, v147
    v_and_b32 v195, v15, v143
    v_and_b32 v203, v15, v147
    v_lshlrev_b32 v204, 16, v148
    v_lshlrev_b32 v205, 16, v152
    v_lshlrev_b32 v206, 16, v156
    v_lshlrev_b32 v207, 16, v160
    v_mul_f32 v206, v196, v206
    v_mul_f32 v207, v188, v207
    v_fma_f32 v188, v188, v204, -v206
    v_fma_f32 v196, v196, v205, v207
    v_mul_f32 v188, s3, v188
    v_mul_f32 v196, s3, v196
    v_and_b32 v204, v15, v148
    v_and_b32 v205, v15, v152
    v_and_b32 v206, v15, v156
    v_and_b32 v207, v15, v160
    v_mul_f32 v206, v197, v206
    v_mul_f32 v207, v189, v207
    v_fma_f32 v189, v189, v204, -v206
    v_fma_f32 v197, v197, v205, v207
    v_mul_f32 v189, s3, v189
    v_mul_f32 v197, s3, v197
    v_lshlrev_b32 v204, 16, v149
    v_lshlrev_b32 v205, 16, v153
    v_lshlrev_b32 v206, 16, v157
    v_lshlrev_b32 v207, 16, v161
    v_mul_f32 v206, v198, v206
    v_mul_f32 v207, v190, v207
    v_fma_f32 v190, v190, v204, -v206
    v_fma_f32 v198, v198, v205, v207
    v_mul_f32 v190, s3, v190
    v_mul_f32 v198, s3, v198
    v_and_b32 v204, v15, v149
    v_and_b32 v205, v15, v153
    v_and_b32 v206, v15, v157
    v_and_b32 v207, v15, v161
    v_mul_f32 v206, v199, v206
    v_mul_f32 v207, v191, v207
    v_fma_f32 v191, v191, v204, -v206
    v_fma_f32 v199, v199, v205, v207
    v_mul_f32 v191, s3, v191
    v_mul_f32 v199, s3, v199
    v_lshlrev_b32 v204, 16, v150
    v_lshlrev_b32 v205, 16, v154
    v_lshlrev_b32 v206, 16, v158
    v_lshlrev_b32 v207, 16, v162
    v_mul_f32 v206, v200, v206
    v_mul_f32 v207, v192, v207
    v_fma_f32 v192, v192, v204, -v206
    v_fma_f32 v200, v200, v205, v207
    v_mul_f32 v192, s3, v192
    v_mul_f32 v200, s3, v200
    v_and_b32 v204, v15, v150
    v_and_b32 v205, v15, v154
    v_and_b32 v206, v15, v158
    v_and_b32 v207, v15, v162
    v_mul_f32 v206, v201, v206
    v_mul_f32 v207, v193, v207
    v_fma_f32 v193, v193, v204, -v206
    v_fma_f32 v201, v201, v205, v207
    v_mul_f32 v193, s3, v193
    v_mul_f32 v201, s3, v201
    v_lshlrev_b32 v204, 16, v151
    v_lshlrev_b32 v205, 16, v155
    v_lshlrev_b32 v206, 16, v159
    v_lshlrev_b32 v207, 16, v163
    v_mul_f32 v206, v202, v206
    v_mul_f32 v207, v194, v207
    v_fma_f32 v194, v194, v204, -v206
    v_fma_f32 v202, v202, v205, v207
    v_mul_f32 v194, s3, v194
    v_mul_f32 v202, s3, v202
    v_and_b32 v204, v15, v151
    v_and_b32 v205, v15, v155
    v_and_b32 v206, v15, v159
    v_and_b32 v207, v15, v163
    v_mul_f32 v206, v203, v206
    v_mul_f32 v207, v195, v207
    v_fma_f32 v195, v195, v204, -v206
    v_fma_f32 v203, v203, v205, v207
    v_mul_f32 v195, s3, v195
    v_mul_f32 v203, s3, v203
    v_cvt_pk_bf16_f32 v140, v188, v189
    v_cvt_pk_bf16_f32 v141, v190, v191
    v_cvt_pk_bf16_f32 v142, v196, v197
    v_cvt_pk_bf16_f32 v143, v198, v199
    ds_write_b128 v210, v[140:143]
    v_cvt_pk_bf16_f32 v144, v192, v193
    v_cvt_pk_bf16_f32 v145, v194, v195
    v_cvt_pk_bf16_f32 v146, v200, v201
    v_cvt_pk_bf16_f32 v147, v202, v203
    ds_write_b128 v211, v[144:147]
L_qj0:
    s_lshl_b32 s98, s10, 6
    s_lshl_b32 s99, s8, 4
    s_add_u32 s98, s98, s99
    s_add_u32 s98, s98, 8
    v_add_u32 v188, s98, v3
    v_cvt_f32_u32 v188, v188
    v_mul_f32 v60, v188, v244
    v_mul_f32 v61, v188, v245
    v_mul_f32 v62, v188, v246
    v_mul_f32 v63, v188, v247
    v_mul_f32 v64, v188, v248
    v_mul_f32 v65, v188, v249
    s_lshl_b32 s13, s10, 5
    s_nop 0
    s_add_u32 s13, s13, 1024
    s_lshl_b32 s11, s9, 13
    s_lshl_b32 s12, s13, 2
    s_add_u32 s11, s11, s12
    s_nop 0
    buffer_load_dwordx4 v[228:231], v13, s[36:39], s11 offen offset:0
    v_mul_f32 v66, v188, v250
    v_mul_f32 v67, v188, v251
    v_fract_f32 v60, v60
    v_fract_f32 v61, v61
    v_fract_f32 v62, v62
    v_fract_f32 v63, v63
    v_fract_f32 v64, v64
    v_fract_f32 v65, v65
    v_fract_f32 v66, v66
    v_fract_f32 v67, v67
    v_cos_f32 v52, v60
    v_cos_f32 v53, v61
    v_cos_f32_e64 v54, v62
    buffer_load_dwordx4 v[236:239], v13, s[40:43], s11 offen offset:0
    v_cos_f32 v55, v63
    v_cos_f32 v56, v64
    v_cos_f32 v57, v65
    v_cos_f32 v58, v66
    v_cos_f32 v59, v67
    v_sin_f32 v60, v60
    v_sin_f32 v61, v61
    v_sin_f32 v62, v62
    v_sin_f32 v63, v63
    v_sin_f32 v64, v64
    v_sin_f32 v65, v65
    v_sin_f32 v66, v66
    v_sin_f32_e64 v67, v67
    buffer_load_dwordx4 v[232:235], v13, s[36:39], s11 offen offset:64
    s_nop 0
    s_nop 0
    v_cvt_pk_bf16_f32 v189, v52, v53
    v_cvt_pk_bf16_f32 v190, v54, v55
    v_cvt_pk_bf16_f32 v191, v56, v57
    v_cvt_pk_bf16_f32 v192, v58, v59
    v_lshlrev_b32 v52, 16, v189
    v_and_b32 v53, v15, v189
    v_lshlrev_b32 v54, 16, v190
    v_and_b32 v55, v15, v190
    v_lshlrev_b32 v56, 16, v191
    v_and_b32 v57, v15, v191
    v_lshlrev_b32 v58, 16, v192
    v_and_b32 v59, v15, v192
    buffer_load_dwordx4 v[240:243], v13, s[40:43], s11 offen offset:64
    v_cvt_pk_bf16_f32 v189, v60, v61
    v_cvt_pk_bf16_f32 v190, v62, v63
    v_cvt_pk_bf16_f32 v191, v64, v65
    v_cvt_pk_bf16_f32 v192, v66, v67
    v_lshlrev_b32 v60, 16, v189
    v_and_b32 v61, v15, v189
    v_lshlrev_b32 v62, 16, v190
    v_and_b32 v63, v15, v190
    v_lshlrev_b32 v64, 16, v191
    v_and_b32 v65, v15, v191
    v_lshlrev_b32 v66, 16, v192
    v_and_b32 v67, v15, v192
    s_lshl_b32 s11, s9, 20
    s_lshl_b32 s12, s13, 9
    s_add_u32 s11, s11, s12
    s_lshl_b32 s12, s8, 7
    s_add_u32 s11, s11, s12
    s_nop 0
    s_add_u32 s12, s11, 8192
    buffer_load_dwordx2 v[212:213], v12, s[32:35], s11 offen offset:0 nt
    s_cmp_lg_u32 s96, 0
    s_cbranch_scc1 L_qfb1
    v_lshlrev_b32 v208, 1, v4
    v_add_u32 v209, v208, v3
    v_add_u32 v209, 8, v209
    v_and_b32 v209, 15, v209
    v_lshlrev_b32_e64 v209, 4, v209
    v_lshl_add_u32 v210, v208, 8, v209
    v_lshlrev_b32 v208, 1, v4
    v_add_u32 v208, 1, v208
    v_add_u32 v209, v208, v3
    v_add_u32 v209, 8, v209
    v_and_b32 v209, 15, v209
    v_lshlrev_b32 v209, 4, v209
    v_lshl_add_u32 v211, v208, 8, v209
    s_lshl_b32 s98, s8, 12
    s_nop 0
    s_add_u32 s98, s98, 9216
    v_add_u32 v210, s98, v210
    v_add_u32 v211, s98, v211
    s_mov_b32 s3, 0x3e0293ee
    s_waitcnt vmcnt(17)
    v_lshlrev_b32 v188, 16, v164
    v_lshlrev_b32 v196, 16, v168
    v_and_b32 v189, v15, v164
    v_and_b32 v197, v15, v168
    v_lshlrev_b32 v190, 16, v165
    v_lshlrev_b32 v198, 16, v169
    v_and_b32 v191, v15, v165
    v_and_b32 v199, v15, v169
    v_lshlrev_b32 v192, 16, v166
    v_lshlrev_b32_e64 v200, 16, v170
    buffer_load_dwordx2 v[214:215], v12, s[32:35], s11 offen offset:512 nt
    v_and_b32 v193, v15, v166
    v_and_b32 v201, v15, v170
    v_lshlrev_b32 v194, 16, v167
    v_lshlrev_b32 v202, 16, v171
    v_and_b32 v195, v15, v167
    v_and_b32 v203, v15, v171
    v_mul_f32 v206, v196, v60
    v_mul_f32 v207, v188, v60
    v_fma_f32 v188, v188, v52, -v206
    v_fma_f32 v196, v196, v52, v207
    v_mul_f32_e64 v188, s3, v188
    buffer_load_dwordx2 v[216:217], v12, s[32:35], s11 offen offset:1024 nt
    v_mul_f32 v196, s3, v196
    v_mul_f32 v206, v197, v61
    v_mul_f32_e64 v207, v189, v61
    v_fma_f32 v189, v189, v53, -v206
    v_fma_f32 v197, v197, v53, v207
    v_mul_f32 v189, s3, v189
    v_mul_f32 v197, s3, v197
    v_mul_f32 v206, v198, v62
    v_mul_f32 v207, v190, v62
    v_fma_f32 v190, v190, v54, -v206
    v_fma_f32 v198, v198, v54, v207
    buffer_load_dwordx2 v[218:219], v12, s[32:35], s11 offen offset:1536 nt
    v_mul_f32 v190, s3, v190
    v_mul_f32 v198, s3, v198
    v_mul_f32 v206, v199, v63
    v_mul_f32 v207, v191, v63
    v_fma_f32 v191, v191, v55, -v206
    v_fma_f32 v199, v199, v55, v207
    v_mul_f32 v191, s3, v191
    v_mul_f32 v199, s3, v199
    v_mul_f32 v206, v200, v64
    v_mul_f32 v207, v192, v64
    buffer_load_dwordx2 v[220:221], v12, s[32:35], s12 offen offset:0 nt
    v_fma_f32 v192, v192, v56, -v206
    v_fma_f32 v200, v200, v56, v207
    v_mul_f32 v192, s3, v192
    v_mul_f32 v200, s3, v200
    v_mul_f32 v206, v201, v65
    v_mul_f32 v207, v193, v65
    v_fma_f32 v193, v193, v57, -v206
    v_fma_f32 v201, v201, v57, v207
    v_mul_f32 v193, s3, v193
    v_mul_f32 v201, s3, v201
    v_mul_f32_e64 v206, v202, v66
    buffer_load_dwordx2 v[222:223], v12, s[32:35], s12 offen offset:512 nt
    v_mul_f32_e64 v207, v194, v66
    v_fma_f32 v194, v194, v58, -v206
    v_fma_f32 v202, v202, v58, v207
    v_mul_f32 v194, s3, v194
    v_mul_f32 v202, s3, v202
    v_mul_f32 v206, v203, v67
    v_mul_f32 v207, v195, v67
    v_fma_f32 v195, v195, v59, -v206
    v_fma_f32 v203, v203, v59, v207
    v_mul_f32 v195, s3, v195
    v_mul_f32 v203, s3, v203
    buffer_load_dwordx2 v[224:225], v12, s[32:35], s12 offen offset:1024 nt
    v_cvt_pk_bf16_f32 v164, v188, v189
    v_cvt_pk_bf16_f32 v165, v190, v191
    v_cvt_pk_bf16_f32 v166, v196, v197
    v_cvt_pk_bf16_f32 v167, v198, v199
    ds_write_b128 v210, v[164:167]
    v_cvt_pk_bf16_f32 v168, v192, v193
    v_cvt_pk_bf16_f32 v169, v194, v195
    v_cvt_pk_bf16_f32 v170, v200, v201
    v_cvt_pk_bf16_f32 v171, v202, v203
    ds_write_b128 v211, v[168:171]
    buffer_load_dwordx2 v[226:227], v12, s[32:35], s12 offen offset:1536 nt
    s_branch L_qj1
L_qfb1:
    s_nop 0
    buffer_load_dwordx2 v[214:215], v12, s[32:35], s11 offen offset:512 nt
    buffer_load_dwordx2 v[216:217], v12, s[32:35], s11 offen offset:1024 nt
    buffer_load_dwordx2 v[218:219], v12, s[32:35], s11 offen offset:1536 nt
    buffer_load_dwordx2 v[220:221], v12, s[32:35], s12 offen offset:0 nt
    buffer_load_dwordx2 v[222:223], v12, s[32:35], s12 offen offset:512 nt
    buffer_load_dwordx2 v[224:225], v12, s[32:35], s12 offen offset:1024 nt
    buffer_load_dwordx2 v[226:227], v12, s[32:35], s12 offen offset:1536 nt
    s_lshl_b32 s98, s10, 6
    s_lshl_b32 s99, s8, 4
    s_add_u32 s98, s98, s99
    s_lshl_b32 s99, s98, 8
    buffer_load_dwordx4 v[172:175], v14, s[44:47], s99 offen offset:2048
    buffer_load_dwordx4 v[176:179], v14, s[44:47], s99 offen offset:2176
    buffer_load_dwordx4 v[180:183], v14, s[48:51], s99 offen offset:2048
    buffer_load_dwordx4 v[184:187], v14, s[48:51], s99 offen offset:2176
    s_waitcnt vmcnt(0)
    v_lshlrev_b32 v208, 1, v4
    v_add_u32 v209, v208, v3
    v_add_u32 v209, 8, v209
    v_and_b32 v209, 15, v209
    v_lshlrev_b32 v209, 4, v209
    v_lshl_add_u32 v210, v208, 8, v209
    v_lshlrev_b32 v208, 1, v4
    v_add_u32 v208, 1, v208
    v_add_u32 v209, v208, v3
    v_add_u32 v209, 8, v209
    v_and_b32 v209, 15, v209
    v_lshlrev_b32 v209, 4, v209
    v_lshl_add_u32 v211, v208, 8, v209
    s_lshl_b32 s98, s8, 12
    s_nop 0
    s_add_u32 s98, s98, 9216
    v_add_u32 v210, s98, v210
    v_add_u32 v211, s98, v211
    s_mov_b32 s3, 0x3e0293ee
    v_lshlrev_b32 v188, 16, v164
    v_lshlrev_b32 v196, 16, v168
    v_and_b32 v189, v15, v164
    v_and_b32 v197, v15, v168
    v_lshlrev_b32 v190, 16, v165
    v_lshlrev_b32 v198, 16, v169
    v_and_b32 v191, v15, v165
    v_and_b32 v199, v15, v169
    v_lshlrev_b32 v192, 16, v166
    v_lshlrev_b32 v200, 16, v170
    v_and_b32 v193, v15, v166
    v_and_b32 v201, v15, v170
    v_lshlrev_b32 v194, 16, v167
    v_lshlrev_b32 v202, 16, v171
    v_and_b32 v195, v15, v167
    v_and_b32 v203, v15, v171
    v_lshlrev_b32 v204, 16, v172
    v_lshlrev_b32 v205, 16, v176
    v_lshlrev_b32 v206, 16, v180
    v_lshlrev_b32 v207, 16, v184
    v_mul_f32 v206, v196, v206
    v_mul_f32 v207, v188, v207
    v_fma_f32 v188, v188, v204, -v206
    v_fma_f32 v196, v196, v205, v207
    v_mul_f32 v188, s3, v188
    v_mul_f32 v196, s3, v196
    v_and_b32 v204, v15, v172
    v_and_b32 v205, v15, v176
    v_and_b32 v206, v15, v180
    v_and_b32 v207, v15, v184
    v_mul_f32 v206, v197, v206
    v_mul_f32 v207, v189, v207
    v_fma_f32 v189, v189, v204, -v206
    v_fma_f32 v197, v197, v205, v207
    v_mul_f32 v189, s3, v189
    v_mul_f32 v197, s3, v197
    v_lshlrev_b32 v204, 16, v173
    v_lshlrev_b32 v205, 16, v177
    v_lshlrev_b32 v206, 16, v181
    v_lshlrev_b32 v207, 16, v185
    v_mul_f32 v206, v198, v206
    v_mul_f32 v207, v190, v207
    v_fma_f32 v190, v190, v204, -v206
    v_fma_f32 v198, v198, v205, v207
    v_mul_f32 v190, s3, v190
    v_mul_f32 v198, s3, v198
    v_and_b32 v204, v15, v173
    v_and_b32 v205, v15, v177
    v_and_b32 v206, v15, v181
    v_and_b32 v207, v15, v185
    v_mul_f32 v206, v199, v206
    v_mul_f32 v207, v191, v207
    v_fma_f32 v191, v191, v204, -v206
    v_fma_f32 v199, v199, v205, v207
    v_mul_f32 v191, s3, v191
    v_mul_f32 v199, s3, v199
    v_lshlrev_b32 v204, 16, v174
    v_lshlrev_b32 v205, 16, v178
    v_lshlrev_b32 v206, 16, v182
    v_lshlrev_b32 v207, 16, v186
    v_mul_f32 v206, v200, v206
    v_mul_f32 v207, v192, v207
    v_fma_f32 v192, v192, v204, -v206
    v_fma_f32 v200, v200, v205, v207
    v_mul_f32 v192, s3, v192
    v_mul_f32 v200, s3, v200
    v_and_b32 v204, v15, v174
    v_and_b32 v205, v15, v178
    v_and_b32 v206, v15, v182
    v_and_b32 v207, v15, v186
    v_mul_f32 v206, v201, v206
    v_mul_f32 v207, v193, v207
    v_fma_f32 v193, v193, v204, -v206
    v_fma_f32 v201, v201, v205, v207
    v_mul_f32 v193, s3, v193
    v_mul_f32 v201, s3, v201
    v_lshlrev_b32 v204, 16, v175
    v_lshlrev_b32 v205, 16, v179
    v_lshlrev_b32 v206, 16, v183
    v_lshlrev_b32 v207, 16, v187
    v_mul_f32 v206, v202, v206
    v_mul_f32 v207, v194, v207
    v_fma_f32 v194, v194, v204, -v206
    v_fma_f32 v202, v202, v205, v207
    v_mul_f32 v194, s3, v194
    v_mul_f32 v202, s3, v202
    v_and_b32 v204, v15, v175
    v_and_b32 v205, v15, v179
    v_and_b32 v206, v15, v183
    v_and_b32 v207, v15, v187
    v_mul_f32 v206, v203, v206
    v_mul_f32 v207, v195, v207
    v_fma_f32 v195, v195, v204, -v206
    v_fma_f32 v203, v203, v205, v207
    v_mul_f32 v195, s3, v195
    v_mul_f32 v203, s3, v203
    v_cvt_pk_bf16_f32 v164, v188, v189
    v_cvt_pk_bf16_f32 v165, v190, v191
    v_cvt_pk_bf16_f32 v166, v196, v197
    v_cvt_pk_bf16_f32 v167, v198, v199
    ds_write_b128 v210, v[164:167]
    v_cvt_pk_bf16_f32 v168, v192, v193
    v_cvt_pk_bf16_f32 v169, v194, v195
    v_cvt_pk_bf16_f32 v170, v200, v201
    v_cvt_pk_bf16_f32 v171, v202, v203
    ds_write_b128 v211, v[168:171]
L_qj1:
    s_add_u32 s48, s4, 12582912
    s_addc_u32 s49, s5, 0
    s_lshr_b32 s50, s2, 3
    s_lshl_b32 s50, s50, 7
    s_waitcnt lgkmcnt(0)
    s_barrier
    v_add_u32 v16, 0, v5
    v_add_u32 v17, v16, v6
    v_and_b32 v17, 15, v17
    v_lshlrev_b32_e64 v17, 4, v17
    v_lshl_add_u32 v18, v16, 8, v17
    v_add_u32 v16, 4, v5
    v_add_u32 v17, v16, v6
    v_and_b32 v17, 15, v17
    v_lshlrev_b32 v17, 4, v17
    v_lshl_add_u32 v19, v16, 8, v17
    v_add_u32 v16, 8, v5
    v_add_u32 v17, v16, v6
    v_and_b32 v17, 15, v17
    v_lshlrev_b32 v17, 4, v17
    v_lshl_add_u32 v20, v16, 8, v17
    v_add_u32 v16, 12, v5
    v_add_u32 v17, v16, v6
    v_and_b32 v17, 15, v17
    v_lshlrev_b32 v17, 4, v17
    v_lshl_add_u32 v21, v16, 8, v17
    s_add_u32 s98, s8, 1
    s_and_b32 s98, s98, 3
    s_lshl_b32 s98, s98, 12
    s_nop 0
    s_add_u32 s98, s98, 9216
    v_add_u32 v24, s98, v18
    v_add_u32 v25, s98, v19
    v_add_u32 v26, s98, v20
    v_add_u32 v27, s98, v21
    s_add_u32 s98, s8, 2
    s_and_b32 s98, s98, 3
    s_lshl_b32 s98, s98, 12
    s_nop 0
    s_add_u32 s98, s98, 9216
    v_add_u32 v28, s98, v18
    v_add_u32 v29, s98, v19
    v_add_u32 v30, s98, v20
    v_add_u32 v31, s98, v21
    s_add_u32 s98, s8, 3
    s_and_b32 s98, s98, 3
    s_lshl_b32 s98, s98, 12
    s_nop 0
    s_add_u32 s98, s98, 9216
    v_add_u32 v32, s98, v18
    v_add_u32 v33, s98, v19
    v_add_u32 v34, s98, v20
    v_add_u32 v35, s98, v21
    s_add_u32 s98, s8, 4
    s_and_b32 s98, s98, 3
    s_lshl_b32 s98, s98, 12
    s_nop 0
    s_add_u32 s98, s98, 9216
    v_add_u32 v36, s98, v18
    v_add_u32 v37, s98, v19
    v_add_u32 v38, s98, v20
    v_add_u32 v39, s98, v21
    ds_read_b128 a[0:3], v24
    ds_read_b128 a[4:7], v25
    ds_read_b128 a[8:11], v26
    ds_read_b128 a[12:15], v27
    ds_read_b128 a[16:19], v28
    ds_read_b128 a[20:23], v29
    ds_read_b128 a[24:27], v30
    ds_read_b128 a[28:31], v31
    ds_read_b128 a[32:35], v32
    ds_read_b128 a[36:39], v33
    ds_read_b128 a[40:43], v34
    ds_read_b128 a[44:47], v35
    ds_read_b128 a[48:51], v36
    ds_read_b128 a[52:55], v37
    ds_read_b128 a[56:59], v38
    ds_read_b128 a[60:63], v39
    s_lshl_b32 s98, s9, 20
    s_lshl_b32 s99, s8, 17
    s_add_u32 s98, s98, s99
    s_nop 0
    s_add_u32 s98, s98, 4096
    s_add_u32 s44, s4, s98
    s_addc_u32 s45, s5, 0
    s_add_u32 s46, s44, 8192
    s_addc_u32 s47, s45, 0
    s_mov_b32 s16, s14
    s_mov_b32 s17, s15
    s_nop 0
    s_and_b32 s17, s17, 0xffff
    s_mov_b32 s18, 4194304
    s_mov_b32 s19, 0x00020000
    s_and_b32 s11, s10, 7
    s_nop 0
    v_add_u32 v1, 524288, v2
    v_and_b32 v7, 31, v0
    v_lshlrev_b32 v7, 7, v7
    v_mov_b32 v16, 0x3f803f80
    v_accvgpr_write_b32 a208, v16
    v_accvgpr_write_b32 a209, v16
    v_accvgpr_write_b32 a210, v16
    v_accvgpr_write_b32 a211, v16
    s_mov_b32 s13, 0
L_touch:
    s_cmp_lg_u32 s8, 0
    s_cbranch_scc1 L_ready
    s_mov_b32 s99, 0
L_poll:
    global_load_dword v16, v7, s[48:49] sc1
    s_waitcnt vmcnt(0)
    v_cmp_le_u32 vcc, 8, v16
    s_add_u32 s99, s99, 1
    s_cmp_eq_u64 vcc, -1
    s_cbranch_scc1 L_ready
    s_nop 0
    s_cmp_lt_u32 s99, 0x40000
    s_cbranch_scc1 L_poll
L_ready:
    s_waitcnt lgkmcnt(0)
    s_barrier
    s_add_u32 s12, s11, 0
    s_and_b32 s12, s12, 7
    s_lshl_b32 s12, s12, 14
    v_add_u32_e64 v3, s12, v2
    global_load_dwordx4 a[64:67], v3, s[44:45] offset:-4096 sc1
    global_load_dwordx4 a[68:71], v3, s[44:45] offset:-3072 sc1
    global_load_dwordx4 a[72:75], v3, s[44:45] offset:-2048 sc1
    global_load_dwordx4 a[76:79], v3, s[44:45] offset:-1024 sc1
    global_load_dwordx4 a[80:83], v3, s[44:45] offset:0 sc1
    global_load_dwordx4 a[84:87], v3, s[44:45] offset:1024 sc1
    global_load_dwordx4 a[88:91], v3, s[44:45] offset:2048 sc1
    global_load_dwordx4 a[92:95], v3, s[44:45] offset:3072 sc1
    v_mov_b32 v4, v3
    s_add_u32 s12, s11, 1
    s_and_b32 s12, s12, 7
    s_lshl_b32 s12, s12, 14
    v_add_u32 v14, s12, v2
    s_lshr_b32 s101, s2, 3
    s_lshl_b32 s101, s101, 14
    s_lshr_b32 s3, s2, 2
    s_and_b32 s3, s3, 1
    s_lshl_b32 s3, s3, 12
    s_add_u32 s101, s101, s3
    s_and_b32 s3, s2, 3
    s_lshl_b32 s3, s3, 6
    s_add_u32 s101, s101, s3
    s_lshl_b32 s3, s8, 21
    s_add_u32 s101, s101, s3
    s_add_u32 s101, s101, 524288
    s_waitcnt vmcnt(24)
    v_lshlrev_b32 v52, 16, v114
    v_and_b32 v53, v15, v114
    v_lshlrev_b32 v54, 16, v115
    v_and_b32 v55, v15, v115
    v_lshlrev_b32 v56, 16, v116
    v_and_b32 v57, v15, v116
    v_lshlrev_b32 v58, 16, v117
    v_and_b32 v59, v15, v117
    v_lshlrev_b32 v60, 16, v118
    v_and_b32 v61, v15, v118
    v_lshlrev_b32 v62, 16, v119
    v_and_b32 v63, v15, v119
    v_lshlrev_b32 v64, 16, v120
    v_and_b32 v65, v15, v120
    v_lshlrev_b32 v66, 16, v121
    v_and_b32_e64 v67, v15, v121
    v_mov_b32_dpp v68, v112 row_newbcast:0 row_mask:0xf bank_mask:0xf
    global_load_dwordx4 a[128:131], v4, s[46:47] offset:-4096 sc1
    v_mov_b32_dpp v69, v113 row_newbcast:0 row_mask:0xf bank_mask:0xf
    s_waitcnt vmcnt(23)
    v_lshlrev_b32 v70, 16, v68
    v_and_b32 v71, v15, v68
    v_lshlrev_b32 v72, 16, v69
    v_and_b32 v73, v15, v69
    v_mul_f32 v72, v72, v70
    v_mul_f32 v73, v73, v71
    v_cvt_f32_i32 v122, v122
    v_cvt_f32_i32 v123, v123
    v_cvt_f32_i32 v124, v124
    v_cvt_f32_i32 v125, v125
    v_cvt_f32_i32 v126, v126
    v_cvt_f32_i32 v127, v127
    v_cvt_f32_i32 v128, v128
    v_cvt_f32_i32_e64 v129, v129
    v_fma_f32 v122, v122, v70, -v72
    v_fma_f32 v126, v126, v71, -v73
    v_fma_f32 v123, v123, v70, -v72
    global_load_dwordx4 a[132:135], v4, s[46:47] offset:-3072 sc1
    v_fma_f32 v127, v127, v71, -v73
    v_fma_f32 v124, v124, v70, -v72
    v_fma_f32 v128, v128, v71, -v73
    v_fma_f32 v125, v125, v70, -v72
    v_fma_f32 v129, v129, v71, -v73
    v_mul_f32 v68, v126, v60
    v_mul_f32 v69, v122, v64
    v_fma_f32 v122, v122, v52, -v68
    v_fma_f32 v126, v126, v56, v69
    v_mul_f32 v68, v127, v61
    v_mul_f32 v69, v123, v65
    v_fma_f32 v123, v123, v53, -v68
    v_fma_f32 v127, v127, v57, v69
    v_mul_f32 v68, v128, v62
    v_mul_f32 v69, v124, v66
    v_fma_f32 v124, v124, v54, -v68
    v_fma_f32 v128, v128, v58, v69
    v_mul_f32_e64 v68, v129, v63
    global_load_dwordx4 a[136:139], v4, s[46:47] offset:-2048 sc1
    v_mul_f32_e64 v69, v125, v67
    v_fma_f32 v125, v125, v55, -v68
    v_fma_f32 v129, v129, v59, v69
    v_cvt_pk_bf16_f32 v122, v122, v123
    v_cvt_pk_bf16_f32 v123, v124, v125
    v_cvt_pk_bf16_f32 v124, v126, v127
    v_cvt_pk_bf16_f32 v125, v128, v129
    v_mov_b32_dpp v68, v112 row_newbcast:1 row_mask:0xf bank_mask:0xf
    v_mov_b32_dpp v69, v113 row_newbcast:1 row_mask:0xf bank_mask:0xf
    s_waitcnt vmcnt(23)
    v_lshlrev_b32 v70, 16, v68
    v_and_b32 v71, v15, v68
    v_lshlrev_b32 v72, 16, v69
    v_and_b32 v73, v15, v69
    v_mul_f32 v72, v72, v70
    v_mul_f32 v73, v73, v71
    v_cvt_f32_i32 v130, v130
    v_cvt_f32_i32 v131, v131
    v_cvt_f32_i32 v132, v132
    global_load_dwordx4 a[140:143], v4, s[46:47] offset:-1024 sc1
    v_cvt_f32_i32 v133, v133
    v_cvt_f32_i32 v134, v134
    v_cvt_f32_i32 v135, v135
    v_cvt_f32_i32 v136, v136
    v_cvt_f32_i32_e64 v137, v137
    v_fma_f32 v130, v130, v70, -v72
    v_fma_f32 v134, v134, v71, -v73
    v_fma_f32 v131, v131, v70, -v72
    v_fma_f32 v135, v135, v71, -v73
    v_fma_f32 v132, v132, v70, -v72
    v_fma_f32 v136, v136, v71, -v73
    v_fma_f32 v133, v133, v70, -v72
    v_fma_f32 v137, v137, v71, -v73
    v_mul_f32 v68, v134, v60
    v_mul_f32 v69, v130, v64
    v_fma_f32 v130, v130, v52, -v68
    v_fma_f32 v134, v134, v56, v69
    v_mul_f32_e64 v68, v135, v61
    global_load_dwordx4 a[144:147], v4, s[46:47] offset:0 sc1
    v_mul_f32_e64 v69, v131, v65
    v_fma_f32 v131, v131, v53, -v68
    v_fma_f32 v135, v135, v57, v69
    v_mul_f32 v68, v136, v62
    v_mul_f32 v69, v132, v66
    v_fma_f32 v132, v132, v54, -v68
    v_fma_f32 v136, v136, v58, v69
    v_mul_f32 v68, v137, v63
    v_mul_f32 v69, v133, v67
    v_fma_f32 v133, v133, v55, -v68
    v_fma_f32 v137, v137, v59, v69
    v_cvt_pk_bf16_f32 v130, v130, v131
    v_cvt_pk_bf16_f32 v131, v132, v133
    v_cvt_pk_bf16_f32 v132, v134, v135
    v_cvt_pk_bf16_f32 v133, v136, v137
    s_lshr_b32 s3, s8, 1
    s_lshl_b32 s3, s3, 4
    s_sub_u32 s3, 16, s3
    s_waitcnt vmcnt(21)
    v_lshlrev_b32 v228, s3, v228
    v_lshlrev_b32 v236, s3, v236
    v_and_b32_e64 v228, v15, v228
    global_load_dwordx4 a[148:151], v4, s[46:47] offset:1024 sc1
    v_and_b32 v236, v15, v236
    v_mul_f32 v236, v236, v228
    v_lshlrev_b32 v229, s3, v229
    v_lshlrev_b32 v237, s3, v237
    v_and_b32 v229, v15, v229
    v_and_b32 v237, v15, v237
    v_mul_f32 v237, v237, v229
    v_lshlrev_b32 v230, s3, v230
    v_lshlrev_b32 v238, s3, v238
    v_and_b32 v230, v15, v230
    v_and_b32 v238, v15, v238
    v_mul_f32 v238, v238, v230
    v_lshlrev_b32 v231, s3, v231
    v_lshlrev_b32 v239, s3, v239
    v_and_b32 v231, v15, v231
    v_and_b32 v239, v15, v239
    v_mul_f32 v239, v239, v231
    v_lshlrev_b32 v232, s3, v232
    global_load_dwordx4 a[152:155], v4, s[46:47] offset:2048 sc1
    v_lshlrev_b32 v240, s3, v240
    v_and_b32 v232, v15, v232
    v_and_b32 v240, v15, v240
    v_mul_f32 v240, v240, v232
    v_lshlrev_b32 v233, s3, v233
    v_lshlrev_b32 v241, s3, v241
    v_and_b32 v233, v15, v233
    v_and_b32 v241, v15, v241
    v_mul_f32 v241, v241, v233
    v_lshlrev_b32 v234, s3, v234
    v_lshlrev_b32 v242, s3, v242
    v_and_b32 v234, v15, v234
    v_and_b32 v242, v15, v242
    v_mul_f32 v242, v242, v234
    v_lshlrev_b32 v235, s3, v235
    v_lshlrev_b32 v243, s3, v243
    v_and_b32 v235, v15, v235
    v_and_b32 v243, v15, v243
    global_load_dwordx4 a[156:159], v4, s[46:47] offset:3072 sc1
    v_mul_f32 v243, v243, v235
    s_waitcnt vmcnt(16)
    v_cvt_f32_i32 v212, v212
    v_cvt_f32_i32 v213, v213
    v_cvt_f32_i32 v214, v214
    v_cvt_f32_i32 v215, v215
    v_cvt_f32_i32 v216, v216
    v_cvt_f32_i32 v217, v217
    v_cvt_f32_i32 v218, v218
    v_cvt_f32_i32 v219, v219
    v_cvt_f32_i32 v220, v220
    v_cvt_f32_i32 v221, v221
    v_cvt_f32_i32 v222, v222
    v_cvt_f32_i32 v223, v223
    v_cvt_f32_i32 v224, v224
    v_cvt_f32_i32 v225, v225
    v_cvt_f32_i32 v226, v226
    v_cvt_f32_i32 v227, v227
    v_fma_f32 v212, v212, v228, -v236
    global_load_dwordx4 a[96:99], v14, s[44:45] offset:-4096 sc1
    v_fma_f32 v213, v213, v228, -v236
    v_fma_f32 v214, v214, v229, -v237
    v_fma_f32 v215, v215, v229, -v237
    v_fma_f32 v216, v216, v230, -v238
    v_fma_f32 v217, v217, v230, -v238
    v_fma_f32 v218, v218, v231, -v239
    v_fma_f32 v219, v219, v231, -v239
    v_fma_f32 v220, v220, v232, -v240
    v_fma_f32 v221, v221, v232, -v240
    v_fma_f32 v222, v222, v233, -v241
    v_fma_f32 v223, v223, v233, -v241
    v_fma_f32 v224, v224, v234, -v242
    v_fma_f32 v225, v225, v234, -v242
    v_fma_f32 v226, v226, v235, -v243
    v_fma_f32 v227, v227, v235, -v243
    s_lshl_b32 s98, s9, 20
    s_lshl_b32 s99, s10, 14
    s_add_u32 s98, s98, s99
    s_lshl_b32 s99, s8, 11
    s_add_u32 s98, s98, s99
    s_nop 0
    s_add_u32 s98, s98, 532480
    v_cvt_pk_bf16_f32 v228, v212, v214
    v_cvt_pk_bf16_f32 v229, v216, v218
    v_cvt_pk_bf16_f32 v230, v220, v222
    global_load_dwordx4 a[100:103], v14, s[44:45] offset:-3072 sc1
    v_cvt_pk_bf16_f32 v231, v224, v226
    v_cvt_pk_bf16_f32 v232, v213, v215
    v_cvt_pk_bf16_f32 v233, v217, v219
    v_cvt_pk_bf16_f32 v234, v221, v223
    v_cvt_pk_bf16_f32 v235, v225, v227
    s_mov_b32 s100, s98
    v_mov_b32 v80, v122
    v_mov_b32 v81, v123
    v_mov_b32 v82, v124
    v_mov_b32 v83, v125
    v_mov_b32 v84, v130
    v_mov_b32 v85, v131
    v_mov_b32 v86, v132
    v_mov_b32 v87, v133
    v_mov_b32 v88, v228
    v_mov_b32 v89, v229
    v_mov_b32 v90, v230
    v_mov_b32 v91, v231
    v_mov_b32 v92, v232
    v_mov_b32 v93, v233
    v_mov_b32 v94, v234
    v_mov_b32 v95, v235
    v_mov_b32 v64, 0
    v_mov_b32 v65, 0
    v_mov_b32 v66, 0
    v_mov_b32 v67, 0
    v_mov_b32 v68, 0
    v_mov_b32 v69, 0
    v_mov_b32 v70, 0
    v_mov_b32 v71, 0
    v_mov_b32 v72, 0
    v_mov_b32 v73, 0
    v_mov_b32 v74, 0
    v_mov_b32 v75, 0
    v_mov_b32 v76, 0
    v_mov_b32 v77, 0
    v_mov_b32 v78, 0
    v_mov_b32 v79, 0
    s_branch L_main
L_run:
    s_add_u32 s12, s11, 0
    s_and_b32 s12, s12, 7
    s_lshl_b32 s12, s12, 14
    v_add_u32 v3, s12, v2
    global_load_dwordx4 a[64:67], v3, s[44:45] offset:-4096 sc1
    global_load_dwordx4 a[68:71], v3, s[44:45] offset:-3072 sc1
    global_load_dwordx4 a[72:75], v3, s[44:45] offset:-2048 sc1
    global_load_dwordx4 a[76:79], v3, s[44:45] offset:-1024 sc1
    global_load_dwordx4 a[80:83], v3, s[44:45] offset:0 sc1
    global_load_dwordx4 a[84:87], v3, s[44:45] offset:1024 sc1
    global_load_dwordx4 a[88:91], v3, s[44:45] offset:2048 sc1
    global_load_dwordx4 a[92:95], v3, s[44:45] offset:3072 sc1
    v_mov_b32 v4, v3
    s_add_u32 s12, s11, 1
    s_and_b32 s12, s12, 7
    s_lshl_b32 s12, s12, 14
    v_add_u32_e64 v14, s12, v2
    global_load_dwordx4 a[128:131], v4, s[46:47] offset:-4096 sc1
    global_load_dwordx4 a[132:135], v4, s[46:47] offset:-3072 sc1
    global_load_dwordx4 a[136:139], v4, s[46:47] offset:-2048 sc1
    global_load_dwordx4 a[140:143], v4, s[46:47] offset:-1024 sc1
    global_load_dwordx4 a[144:147], v4, s[46:47] offset:0 sc1
    global_load_dwordx4 a[148:151], v4, s[46:47] offset:1024 sc1
    global_load_dwordx4 a[152:155], v4, s[46:47] offset:2048 sc1
    global_load_dwordx4 a[156:159], v4, s[46:47] offset:3072 sc1
    global_load_dwordx4 a[96:99], v14, s[44:45] offset:-4096 sc1
    global_load_dwordx4 a[100:103], v14, s[44:45] offset:-3072 sc1
L_main:
    s_waitcnt vmcnt(10)
    v_mfma_f32_16x16x32_bf16 v[16:19], a[64:67], a[0:3], v[64:67]
    v_mfma_f32_16x16x32_bf16 v[16:19], a[68:71], a[4:7], v[16:19]
    v_mfma_f32_16x16x32_bf16 v[16:19], a[72:75], a[8:11], v[16:19]
    global_load_dwordx4 a[104:107], v14, s[44:45] offset:-2048 sc1
    v_mfma_f32_16x16x32_bf16 v[16:19], a[76:79], a[12:15], v[16:19]
    s_nop 0
    v_mfma_f32_16x16x32_bf16 v[20:23], a[80:83], a[0:3], v[64:67]
    s_nop 0
    v_mfma_f32_16x16x32_bf16 v[20:23], a[84:87], a[4:7], v[20:23]
    s_nop 0
    v_mfma_f32_16x16x32_bf16 v[20:23], a[88:91], a[8:11], v[20:23]
    s_nop 0
    global_load_dwordx4 a[108:111], v14, s[44:45] offset:-1024 sc1
    v_mfma_f32_16x16x32_bf16 v[20:23], a[92:95], a[12:15], v[20:23]
    s_nop 0
    v_mfma_f32_16x16x32_bf16 v[24:27], a[64:67], a[16:19], v[68:71]
    v_exp_f32 v16, v16
    v_mfma_f32_16x16x32_bf16 v[24:27], a[68:71], a[20:23], v[24:27]
    v_exp_f32 v17, v17
    v_mfma_f32_16x16x32_bf16 v[24:27], a[72:75], a[24:27], v[24:27]
    v_cvt_pk_bf16_f32 v48, v16, v17
    v_mfma_f32_16x16x32_bf16 v[24:27], a[76:79], a[28:31], v[24:27]
    global_load_dwordx4 a[112:115], v14, s[44:45] offset:0 sc1
    v_mfma_f32_16x16x32_bf16 v[28:31], a[80:83], a[16:19], v[68:71]
    v_exp_f32 v18, v18
    v_mfma_f32_16x16x32_bf16 v[28:31], a[84:87], a[20:23], v[28:31]
    v_exp_f32 v19, v19
    v_mfma_f32_16x16x32_bf16 v[28:31], a[88:91], a[24:27], v[28:31]
    v_cvt_pk_bf16_f32 v49, v18, v19
    v_mfma_f32_16x16x32_bf16 v[28:31], a[92:95], a[28:31], v[28:31]
    global_load_dwordx4 a[116:119], v14, s[44:45] offset:1024 sc1
    s_nop 1
    v_exp_f32 v20, v20
    s_nop 1
    v_exp_f32 v21, v21
    s_nop 1
    v_cvt_pk_bf16_f32 v50, v20, v21
    s_nop 1
    global_load_dwordx4 a[120:123], v14, s[44:45] offset:2048 sc1
    s_nop 1
    v_exp_f32 v22, v22
    s_nop 1
    v_exp_f32 v23, v23
    s_nop 1
    v_cvt_pk_bf16_f32 v51, v22, v23
    s_nop 1
    global_load_dwordx4 a[124:127], v14, s[44:45] offset:3072 sc1
    s_nop 1
    s_nop 1
    v_exp_f32 v24, v24
    s_nop 1
    v_exp_f32 v25, v25
    s_nop 1
    v_cvt_pk_bf16_f32 v52, v24, v25
    s_nop 1
    global_load_dwordx4 a[160:163], v14, s[46:47] offset:-4096 sc1
    s_nop 1
    v_exp_f32 v26, v26
    s_nop 1
    v_exp_f32 v27, v27
    s_nop 1
    v_cvt_pk_bf16_f32 v53, v26, v27
    s_nop 1
    global_load_dwordx4 a[164:167], v14, s[46:47] offset:-3072 sc1
    s_nop 1
    v_exp_f32 v28, v28
    v_mfma_f32_16x16x32_bf16 v[32:35], a[64:67], a[32:35], v[72:75]
    v_exp_f32 v29, v29
    v_mfma_f32_16x16x32_bf16 v[32:35], a[68:71], a[36:39], v[32:35]
    v_cvt_pk_bf16_f32 v54, v28, v29
    v_mfma_f32_16x16x32_bf16 v[32:35], a[72:75], a[40:43], v[32:35]
    global_load_dwordx4 a[168:171], v14, s[46:47] offset:-2048 sc1
    v_mfma_f32_16x16x32_bf16 v[32:35], a[76:79], a[44:47], v[32:35]
    v_exp_f32 v30, v30
    v_mfma_f32_16x16x32_bf16 v[36:39], a[80:83], a[32:35], v[72:75]
    v_exp_f32 v31, v31
    v_mfma_f32_16x16x32_bf16 v[36:39], a[84:87], a[36:39], v[36:39]
    v_cvt_pk_bf16_f32 v55, v30, v31
    v_mfma_f32_16x16x32_bf16 v[36:39], a[88:91], a[40:43], v[36:39]
    global_load_dwordx4 a[172:175], v14, s[46:47] offset:-1024 sc1
    s_cmp_lg_u32 s13, 0
    s_cbranch_scc1 L_nolate0
    buffer_store_dwordx4 v[80:83], v11, s[60:63], s101 offen sc1
    s_branch L_latejoin0
L_nolate0:
    global_load_dword v125, v7, s[48:49] sc1
L_latejoin0:
    v_mfma_f32_16x16x32_bf16 v[36:39], a[92:95], a[44:47], v[36:39]
    s_cmp_lg_u32 s13, 0
    s_cbranch_scc1 L_nolate1
    s_add_u32 s101, s101, 0x100000
    buffer_store_dwordx4 v[84:87], v11, s[60:63], s101 offen sc1
    s_branch L_latejoin1
L_nolate1:
    global_load_dword v125, v7, s[48:49] sc1
L_latejoin1:
    v_mfma_f32_16x16x32_bf16 v[40:43], a[64:67], a[48:51], v[76:79]
    v_exp_f32 v32, v32
    s_cmp_lg_u32 s13, 0
    s_cbranch_scc1 L_nolate2
    buffer_store_dwordx4 v[88:91], v2, s[60:63], s100 offen sc1
    s_branch L_latejoin2
L_nolate2:
    global_load_dword v125, v7, s[48:49] sc1
L_latejoin2:
    v_mfma_f32_16x16x32_bf16 v[40:43], a[68:71], a[52:55], v[40:43]
    v_exp_f32 v33, v33
    s_cmp_lg_u32 s13, 0
    s_cbranch_scc1 L_nolate3
    buffer_store_dwordx4 v[92:95], v2, s[60:63], s100 offen offset:1024 sc1
    s_branch L_latejoin3
L_nolate3:
    global_load_dword v125, v7, s[48:49] sc1
L_latejoin3:
    v_mfma_f32_16x16x32_bf16 v[40:43], a[72:75], a[56:59], v[40:43]
    v_cvt_pk_bf16_f32 v56, v32, v33
    v_mfma_f32_16x16x32_bf16 v[40:43], a[76:79], a[60:63], v[40:43]
    global_load_dwordx4 a[176:179], v14, s[46:47] offset:0 sc1
    v_mfma_f32_16x16x32_bf16 v[44:47], a[80:83], a[48:51], v[76:79]
    v_exp_f32 v34, v34
    v_mfma_f32_16x16x32_bf16 v[44:47], a[84:87], a[52:55], v[44:47]
    v_exp_f32 v35, v35
    v_mfma_f32_16x16x32_bf16 v[44:47], a[88:91], a[56:59], v[44:47]
    v_cvt_pk_bf16_f32 v57, v34, v35
    v_mfma_f32_16x16x32_bf16 v[44:47], a[92:95], a[60:63], v[44:47]
    global_load_dwordx4 a[180:183], v14, s[46:47] offset:1024 sc1
    s_waitcnt vmcnt(18)
    v_mfma_f32_16x16x32_bf16 v[128:131], a[128:131], v[48:51], 0
    v_exp_f32 v36, v36
    v_mfma_f32_16x16x32_bf16 v[132:135], a[132:135], v[48:51], 0
    v_exp_f32 v37, v37
    v_mfma_f32_16x16x32_bf16 v[136:139], a[136:139], v[48:51], 0
    v_cvt_pk_bf16_f32 v58, v36, v37
    v_mfma_f32_16x16x32_bf16 v[140:143], a[140:143], v[48:51], 0
    global_load_dwordx4 a[184:187], v14, s[46:47] offset:2048 sc1
    v_mfma_f32_16x16x32_bf16 v[144:147], a[144:147], v[48:51], 0
    v_exp_f32 v38, v38
    v_mfma_f32_16x16x32_bf16 v[148:151], a[148:151], v[48:51], 0
    v_exp_f32 v39, v39
    v_mfma_f32_16x16x32_bf16 v[152:155], a[152:155], v[48:51], 0
    v_cvt_pk_bf16_f32 v59, v38, v39
    v_mfma_f32_16x16x32_bf16 v[156:159], a[156:159], v[48:51], 0
    global_load_dwordx4 a[188:191], v14, s[46:47] offset:3072 sc1
    v_mfma_f32_16x16x32_bf16 a[192:195], a[208:211], v[48:51], 0
    v_mfma_f32_16x16x32_bf16 v[160:163], a[128:131], v[52:55], 0
    v_exp_f32 v40, v40
    v_mfma_f32_16x16x32_bf16 v[164:167], a[132:135], v[52:55], 0
    v_exp_f32 v41, v41
    v_mfma_f32_16x16x32_bf16 v[168:171], a[136:139], v[52:55], 0
    v_cvt_pk_bf16_f32 v60, v40, v41
    v_mfma_f32_16x16x32_bf16 v[172:175], a[140:143], v[52:55], 0
    s_add_u32 s12, s11, 2
    s_and_b32 s12, s12, 7
    s_lshl_b32 s12, s12, 14
    v_add_u32 v3, s12, v2
    global_load_dwordx4 a[64:67], v3, s[44:45] offset:-4096 sc1
    v_mfma_f32_16x16x32_bf16 v[176:179], a[144:147], v[52:55], 0
    v_exp_f32 v42, v42
    v_mfma_f32_16x16x32_bf16 v[180:183], a[148:151], v[52:55], 0
    v_exp_f32 v43, v43
    v_mfma_f32_16x16x32_bf16 v[184:187], a[152:155], v[52:55], 0
    v_cvt_pk_bf16_f32 v61, v42, v43
    v_mfma_f32_16x16x32_bf16 v[188:191], a[156:159], v[52:55], 0
    global_load_dwordx4 a[68:71], v3, s[44:45] offset:-3072 sc1
    v_mfma_f32_16x16x32_bf16 a[196:199], a[208:211], v[52:55], 0
    v_exp_f32 v44, v44
    s_waitcnt vmcnt(14)
    v_mfma_f32_16x16x32_bf16 v[16:19], a[96:99], a[0:3], v[64:67]
    v_exp_f32 v45, v45
    v_mfma_f32_16x16x32_bf16 v[16:19], a[100:103], a[4:7], v[16:19]
    v_cvt_pk_bf16_f32 v62, v44, v45
    v_mfma_f32_16x16x32_bf16 v[16:19], a[104:107], a[8:11], v[16:19]
    global_load_dwordx4 a[72:75], v3, s[44:45] offset:-2048 sc1
    v_mfma_f32_16x16x32_bf16 v[16:19], a[108:111], a[12:15], v[16:19]
    v_exp_f32 v46, v46
    v_mfma_f32_16x16x32_bf16 v[20:23], a[112:115], a[0:3], v[64:67]
    v_exp_f32 v47, v47
    v_mfma_f32_16x16x32_bf16 v[20:23], a[116:119], a[4:7], v[20:23]
    v_cvt_pk_bf16_f32 v63, v46, v47
    v_mfma_f32_16x16x32_bf16 v[20:23], a[120:123], a[8:11], v[20:23]
    global_load_dwordx4 a[76:79], v3, s[44:45] offset:-1024 sc1
    v_mfma_f32_16x16x32_bf16 v[20:23], a[124:127], a[12:15], v[20:23]
    v_mfma_f32_16x16x32_bf16 v[24:27], a[96:99], a[16:19], v[68:71]
    v_exp_f32 v16, v16
    v_mfma_f32_16x16x32_bf16 v[24:27], a[100:103], a[20:23], v[24:27]
    v_exp_f32 v17, v17
    v_mfma_f32_16x16x32_bf16 v[24:27], a[104:107], a[24:27], v[24:27]
    v_cvt_pk_bf16_f32 v48, v16, v17
    v_mfma_f32_16x16x32_bf16 v[24:27], a[108:111], a[28:31], v[24:27]
    global_load_dwordx4 a[80:83], v3, s[44:45] offset:0 sc1
    v_mfma_f32_16x16x32_bf16 v[28:31], a[112:115], a[16:19], v[68:71]
    v_exp_f32 v18, v18
    v_mfma_f32_16x16x32_bf16 v[28:31], a[116:119], a[20:23], v[28:31]
    v_exp_f32 v19, v19
    v_mfma_f32_16x16x32_bf16 v[28:31], a[120:123], a[24:27], v[28:31]
    v_cvt_pk_bf16_f32 v49, v18, v19
    v_mfma_f32_16x16x32_bf16 v[28:31], a[124:127], a[28:31], v[28:31]
    global_load_dwordx4 a[84:87], v3, s[44:45] offset:1024 sc1
    v_mfma_f32_16x16x32_bf16 v[192:195], a[128:131], v[56:59], 0
    v_exp_f32 v20, v20
    v_mfma_f32_16x16x32_bf16 v[196:199], a[132:135], v[56:59], 0
    v_exp_f32 v21, v21
    v_mfma_f32_16x16x32_bf16 v[200:203], a[136:139], v[56:59], 0
    v_cvt_pk_bf16_f32 v50, v20, v21
    v_mfma_f32_16x16x32_bf16 v[204:207], a[140:143], v[56:59], 0
    global_load_dwordx4 a[88:91], v3, s[44:45] offset:2048 sc1
    v_mfma_f32_16x16x32_bf16 v[208:211], a[144:147], v[56:59], 0
    v_exp_f32 v22, v22
    v_mfma_f32_16x16x32_bf16 v[212:215], a[148:151], v[56:59], 0
    v_exp_f32 v23, v23
    v_mfma_f32_16x16x32_bf16 v[216:219], a[152:155], v[56:59], 0
    v_cvt_pk_bf16_f32 v51, v22, v23
    v_mfma_f32_16x16x32_bf16 v[220:223], a[156:159], v[56:59], 0
    global_load_dwordx4 a[92:95], v3, s[44:45] offset:3072 sc1
    v_mfma_f32_16x16x32_bf16 a[200:203], a[208:211], v[56:59], 0
    v_mfma_f32_16x16x32_bf16 v[224:227], a[128:131], v[60:63], 0
    v_exp_f32 v24, v24
    v_mfma_f32_16x16x32_bf16 v[228:231], a[132:135], v[60:63], 0
    v_exp_f32 v25, v25
    v_mfma_f32_16x16x32_bf16 v[232:235], a[136:139], v[60:63], 0
    v_cvt_pk_bf16_f32 v52, v24, v25
    v_mfma_f32_16x16x32_bf16 v[236:239], a[140:143], v[60:63], 0
    global_load_dwordx4 a[128:131], v3, s[46:47] offset:-4096 sc1
    v_mfma_f32_16x16x32_bf16 v[240:243], a[144:147], v[60:63], 0
    v_exp_f32 v26, v26
    v_mfma_f32_16x16x32_bf16 v[244:247], a[148:151], v[60:63], 0
    v_exp_f32 v27, v27
    v_mfma_f32_16x16x32_bf16 v[248:251], a[152:155], v[60:63], 0
    v_cvt_pk_bf16_f32 v53, v26, v27
    v_mfma_f32_16x16x32_bf16 v[252:255], a[156:159], v[60:63], 0
    global_load_dwordx4 a[132:135], v3, s[46:47] offset:-3072 sc1
    v_mfma_f32_16x16x32_bf16 a[204:207], a[208:211], v[60:63], 0
    v_exp_f32 v28, v28
    v_mfma_f32_16x16x32_bf16 v[32:35], a[96:99], a[32:35], v[72:75]
    v_exp_f32 v29, v29
    v_mfma_f32_16x16x32_bf16 v[32:35], a[100:103], a[36:39], v[32:35]
    v_cvt_pk_bf16_f32 v54, v28, v29
    v_mfma_f32_16x16x32_bf16 v[32:35], a[104:107], a[40:43], v[32:35]
    global_load_dwordx4 a[136:139], v3, s[46:47] offset:-2048 sc1
    v_mfma_f32_16x16x32_bf16 v[32:35], a[108:111], a[44:47], v[32:35]
    v_exp_f32 v30, v30
    v_mfma_f32_16x16x32_bf16 v[36:39], a[112:115], a[32:35], v[72:75]
    v_exp_f32 v31, v31
    v_mfma_f32_16x16x32_bf16 v[36:39], a[116:119], a[36:39], v[36:39]
    v_cvt_pk_bf16_f32 v55, v30, v31
    v_mfma_f32_16x16x32_bf16 v[36:39], a[120:123], a[40:43], v[36:39]
    global_load_dwordx4 a[140:143], v3, s[46:47] offset:-1024 sc1
    v_mfma_f32_16x16x32_bf16 v[36:39], a[124:127], a[44:47], v[36:39]
    v_mfma_f32_16x16x32_bf16 v[40:43], a[96:99], a[48:51], v[76:79]
    v_exp_f32 v32, v32
    v_mfma_f32_16x16x32_bf16 v[40:43], a[100:103], a[52:55], v[40:43]
    v_exp_f32 v33, v33
    v_mfma_f32_16x16x32_bf16 v[40:43], a[104:107], a[56:59], v[40:43]
    v_cvt_pk_bf16_f32 v56, v32, v33
    v_mfma_f32_16x16x32_bf16 v[40:43], a[108:111], a[60:63], v[40:43]
    global_load_dwordx4 a[144:147], v3, s[46:47] offset:0 sc1
    v_mfma_f32_16x16x32_bf16 v[44:47], a[112:115], a[48:51], v[76:79]
    v_exp_f32 v34, v34
    v_mfma_f32_16x16x32_bf16 v[44:47], a[116:119], a[52:55], v[44:47]
    v_exp_f32 v35, v35
    v_mfma_f32_16x16x32_bf16 v[44:47], a[120:123], a[56:59], v[44:47]
    v_cvt_pk_bf16_f32 v57, v34, v35
    v_mfma_f32_16x16x32_bf16 v[44:47], a[124:127], a[60:63], v[44:47]
    global_load_dwordx4 a[148:151], v3, s[46:47] offset:1024 sc1
    s_waitcnt vmcnt(14)
    v_mfma_f32_16x16x32_bf16 v[128:131], a[160:163], v[48:51], v[128:131]
    v_exp_f32 v36, v36
    v_mfma_f32_16x16x32_bf16 v[132:135], a[164:167], v[48:51], v[132:135]
    v_exp_f32 v37, v37
    v_mfma_f32_16x16x32_bf16 v[136:139], a[168:171], v[48:51], v[136:139]
    v_cvt_pk_bf16_f32 v58, v36, v37
    v_mfma_f32_16x16x32_bf16 v[140:143], a[172:175], v[48:51], v[140:143]
    global_load_dwordx4 a[152:155], v3, s[46:47] offset:2048 sc1
    v_mfma_f32_16x16x32_bf16 v[144:147], a[176:179], v[48:51], v[144:147]
    v_exp_f32 v38, v38
    v_mfma_f32_16x16x32_bf16 v[148:151], a[180:183], v[48:51], v[148:151]
    v_exp_f32 v39, v39
    v_mfma_f32_16x16x32_bf16 v[152:155], a[184:187], v[48:51], v[152:155]
    v_cvt_pk_bf16_f32 v59, v38, v39
    v_mfma_f32_16x16x32_bf16 v[156:159], a[188:191], v[48:51], v[156:159]
    global_load_dwordx4 a[156:159], v3, s[46:47] offset:3072 sc1
    v_mfma_f32_16x16x32_bf16 a[192:195], a[208:211], v[48:51], a[192:195]
    v_mfma_f32_16x16x32_bf16 v[160:163], a[160:163], v[52:55], v[160:163]
    v_exp_f32 v40, v40
    v_mfma_f32_16x16x32_bf16 v[164:167], a[164:167], v[52:55], v[164:167]
    v_exp_f32 v41, v41
    v_mfma_f32_16x16x32_bf16 v[168:171], a[168:171], v[52:55], v[168:171]
    v_cvt_pk_bf16_f32 v60, v40, v41
    s_add_u32 s12, s11, 3
    s_and_b32 s12, s12, 7
    s_lshl_b32 s12, s12, 14
    v_add_u32 v3, s12, v2
    v_mfma_f32_16x16x32_bf16 v[172:175], a[172:175], v[52:55], v[172:175]
    global_load_dwordx4 a[96:99], v3, s[44:45] offset:-4096 sc1
    v_mfma_f32_16x16x32_bf16 v[176:179], a[176:179], v[52:55], v[176:179]
    v_exp_f32 v42, v42
    v_mfma_f32_16x16x32_bf16 v[180:183], a[180:183], v[52:55], v[180:183]
    v_exp_f32 v43, v43
    v_mfma_f32_16x16x32_bf16 v[184:187], a[184:187], v[52:55], v[184:187]
    v_cvt_pk_bf16_f32 v61, v42, v43
    v_mfma_f32_16x16x32_bf16 v[188:191], a[188:191], v[52:55], v[188:191]
    global_load_dwordx4 a[100:103], v3, s[44:45] offset:-3072 sc1
    v_mfma_f32_16x16x32_bf16 a[196:199], a[208:211], v[52:55], a[196:199]
    v_exp_f32 v44, v44
    s_waitcnt vmcnt(10)
    v_mfma_f32_16x16x32_bf16 v[16:19], a[64:67], a[0:3], v[64:67]
    v_exp_f32 v45, v45
    v_mfma_f32_16x16x32_bf16 v[16:19], a[68:71], a[4:7], v[16:19]
    v_cvt_pk_bf16_f32 v62, v44, v45
    v_mov_b32 v122, 2048
    v_cmp_eq_u32 vcc, 0, v0
    v_mfma_f32_16x16x32_bf16 v[16:19], a[72:75], a[8:11], v[16:19]
    global_load_dwordx4 a[104:107], v3, s[44:45] offset:-2048 sc1
    s_nop 1
    v_cndmask_b32_e64 v123, 0, 1, vcc
    ds_add_rtn_u32 v124, v122, v123
    v_mfma_f32_16x16x32_bf16 v[16:19], a[76:79], a[12:15], v[16:19]
    v_exp_f32 v46, v46
    v_mfma_f32_16x16x32_bf16 v[20:23], a[80:83], a[0:3], v[64:67]
    v_exp_f32 v47, v47
    v_mfma_f32_16x16x32_bf16 v[20:23], a[84:87], a[4:7], v[20:23]
    v_cvt_pk_bf16_f32 v63, v46, v47
    v_mfma_f32_16x16x32_bf16 v[20:23], a[88:91], a[8:11], v[20:23]
    global_load_dwordx4 a[108:111], v3, s[44:45] offset:-1024 sc1
    v_mfma_f32_16x16x32_bf16 v[20:23], a[92:95], a[12:15], v[20:23]
    v_mfma_f32_16x16x32_bf16 v[24:27], a[64:67], a[16:19], v[68:71]
    v_exp_f32 v16, v16
    v_mfma_f32_16x16x32_bf16 v[24:27], a[68:71], a[20:23], v[24:27]
    v_exp_f32 v17, v17
    v_mfma_f32_16x16x32_bf16 v[24:27], a[72:75], a[24:27], v[24:27]
    v_cvt_pk_bf16_f32 v48, v16, v17
    v_mfma_f32_16x16x32_bf16 v[24:27], a[76:79], a[28:31], v[24:27]
    global_load_dwordx4 a[112:115], v3, s[44:45] offset:0 sc1
    v_mfma_f32_16x16x32_bf16 v[28:31], a[80:83], a[16:19], v[68:71]
    v_exp_f32 v18, v18
    s_waitcnt lgkmcnt(0)
    v_readfirstlane_b32 s98, v124
    s_and_b32 s98, s98, 3
    s_cmp_lg_u32 s98, 3
    s_cbranch_scc1 L_f1_1
    v_mov_b32 v122, s50
    v_mov_b32 v123, 1
    s_mov_b64 exec, 1
    global_atomic_add v122, v123, s[48:49] sc1
    s_mov_b64 exec, -1
    s_nop 3
L_f1_1:
    v_mfma_f32_16x16x32_bf16 v[28:31], a[84:87], a[20:23], v[28:31]
    v_exp_f32 v19, v19
    v_mfma_f32_16x16x32_bf16 v[28:31], a[88:91], a[24:27], v[28:31]
    v_cvt_pk_bf16_f32 v49, v18, v19
    v_mfma_f32_16x16x32_bf16 v[28:31], a[92:95], a[28:31], v[28:31]
    global_load_dwordx4 a[116:119], v3, s[44:45] offset:1024 sc1
    v_mfma_f32_16x16x32_bf16 v[192:195], a[160:163], v[56:59], v[192:195]
    v_exp_f32 v20, v20
    v_mfma_f32_16x16x32_bf16 v[196:199], a[164:167], v[56:59], v[196:199]
    v_exp_f32 v21, v21
    v_mfma_f32_16x16x32_bf16 v[200:203], a[168:171], v[56:59], v[200:203]
    v_cvt_pk_bf16_f32 v50, v20, v21
    v_mfma_f32_16x16x32_bf16 v[204:207], a[172:175], v[56:59], v[204:207]
    global_load_dwordx4 a[120:123], v3, s[44:45] offset:2048 sc1
    v_mfma_f32_16x16x32_bf16 v[208:211], a[176:179], v[56:59], v[208:211]
    v_exp_f32 v22, v22
    v_mfma_f32_16x16x32_bf16 v[212:215], a[180:183], v[56:59], v[212:215]
    v_exp_f32 v23, v23
    v_mfma_f32_16x16x32_bf16 v[216:219], a[184:187], v[56:59], v[216:219]
    v_cvt_pk_bf16_f32 v51, v22, v23
    v_mfma_f32_16x16x32_bf16 v[220:223], a[188:191], v[56:59], v[220:223]
    global_load_dwordx4 a[124:127], v3, s[44:45] offset:3072 sc1
    v_mfma_f32_16x16x32_bf16 a[200:203], a[208:211], v[56:59], a[200:203]
    v_mfma_f32_16x16x32_bf16 v[224:227], a[160:163], v[60:63], v[224:227]
    v_exp_f32 v24, v24
    v_mfma_f32_16x16x32_bf16 v[228:231], a[164:167], v[60:63], v[228:231]
    v_exp_f32 v25, v25
    v_mfma_f32_16x16x32_bf16 v[232:235], a[168:171], v[60:63], v[232:235]
    v_cvt_pk_bf16_f32 v52, v24, v25
    v_mfma_f32_16x16x32_bf16 v[236:239], a[172:175], v[60:63], v[236:239]
    global_load_dwordx4 a[160:163], v3, s[46:47] offset:-4096 sc1
    v_mfma_f32_16x16x32_bf16 v[240:243], a[176:179], v[60:63], v[240:243]
    v_exp_f32 v26, v26
    v_mfma_f32_16x16x32_bf16 v[244:247], a[180:183], v[60:63], v[244:247]
    v_exp_f32 v27, v27
    v_mfma_f32_16x16x32_bf16 v[248:251], a[184:187], v[60:63], v[248:251]
    v_cvt_pk_bf16_f32 v53, v26, v27
    v_mfma_f32_16x16x32_bf16 v[252:255], a[188:191], v[60:63], v[252:255]
    global_load_dwordx4 a[164:167], v3, s[46:47] offset:-3072 sc1
    v_mfma_f32_16x16x32_bf16 a[204:207], a[208:211], v[60:63], a[204:207]
    v_exp_f32 v28, v28
    v_mfma_f32_16x16x32_bf16 v[32:35], a[64:67], a[32:35], v[72:75]
    v_exp_f32 v29, v29
    v_mfma_f32_16x16x32_bf16 v[32:35], a[68:71], a[36:39], v[32:35]
    v_cvt_pk_bf16_f32 v54, v28, v29
    v_mfma_f32_16x16x32_bf16 v[32:35], a[72:75], a[40:43], v[32:35]
    global_load_dwordx4 a[168:171], v3, s[46:47] offset:-2048 sc1
    v_mfma_f32_16x16x32_bf16 v[32:35], a[76:79], a[44:47], v[32:35]
    v_exp_f32 v30, v30
    v_mfma_f32_16x16x32_bf16 v[36:39], a[80:83], a[32:35], v[72:75]
    v_exp_f32 v31, v31
    v_mfma_f32_16x16x32_bf16 v[36:39], a[84:87], a[36:39], v[36:39]
    v_cvt_pk_bf16_f32 v55, v30, v31
    v_mfma_f32_16x16x32_bf16 v[36:39], a[88:91], a[40:43], v[36:39]
    global_load_dwordx4 a[172:175], v3, s[46:47] offset:-1024 sc1
    v_mfma_f32_16x16x32_bf16 v[36:39], a[92:95], a[44:47], v[36:39]
    v_mfma_f32_16x16x32_bf16 v[40:43], a[64:67], a[48:51], v[76:79]
    v_exp_f32 v32, v32
    v_mfma_f32_16x16x32_bf16 v[40:43], a[68:71], a[52:55], v[40:43]
    v_exp_f32 v33, v33
    v_mfma_f32_16x16x32_bf16 v[40:43], a[72:75], a[56:59], v[40:43]
    v_cvt_pk_bf16_f32 v56, v32, v33
    v_mfma_f32_16x16x32_bf16 v[40:43], a[76:79], a[60:63], v[40:43]
    global_load_dwordx4 a[176:179], v3, s[46:47] offset:0 sc1
    v_mfma_f32_16x16x32_bf16 v[44:47], a[80:83], a[48:51], v[76:79]
    v_exp_f32 v34, v34
    v_mfma_f32_16x16x32_bf16 v[44:47], a[84:87], a[52:55], v[44:47]
    v_exp_f32 v35, v35
    v_mfma_f32_16x16x32_bf16 v[44:47], a[88:91], a[56:59], v[44:47]
    v_cvt_pk_bf16_f32 v57, v34, v35
    v_mfma_f32_16x16x32_bf16 v[44:47], a[92:95], a[60:63], v[44:47]
    global_load_dwordx4 a[180:183], v3, s[46:47] offset:1024 sc1
    s_waitcnt vmcnt(14)
    v_mfma_f32_16x16x32_bf16 v[128:131], a[128:131], v[48:51], v[128:131]
    v_exp_f32 v36, v36
    v_mfma_f32_16x16x32_bf16 v[132:135], a[132:135], v[48:51], v[132:135]
    v_exp_f32 v37, v37
    v_mfma_f32_16x16x32_bf16 v[136:139], a[136:139], v[48:51], v[136:139]
    v_cvt_pk_bf16_f32 v58, v36, v37
    v_mfma_f32_16x16x32_bf16 v[140:143], a[140:143], v[48:51], v[140:143]
    global_load_dwordx4 a[184:187], v3, s[46:47] offset:2048 sc1
    v_mfma_f32_16x16x32_bf16 v[144:147], a[144:147], v[48:51], v[144:147]
    v_exp_f32 v38, v38
    v_mfma_f32_16x16x32_bf16 v[148:151], a[148:151], v[48:51], v[148:151]
    v_exp_f32 v39, v39
    v_mfma_f32_16x16x32_bf16 v[152:155], a[152:155], v[48:51], v[152:155]
    v_cvt_pk_bf16_f32 v59, v38, v39
    v_mfma_f32_16x16x32_bf16 v[156:159], a[156:159], v[48:51], v[156:159]
    global_load_dwordx4 a[188:191], v3, s[46:47] offset:3072 sc1
    v_mfma_f32_16x16x32_bf16 a[192:195], a[208:211], v[48:51], a[192:195]
    v_mfma_f32_16x16x32_bf16 v[160:163], a[128:131], v[52:55], v[160:163]
    v_exp_f32 v40, v40
    v_mfma_f32_16x16x32_bf16 v[164:167], a[132:135], v[52:55], v[164:167]
    v_exp_f32 v41, v41
    v_mfma_f32_16x16x32_bf16 v[168:171], a[136:139], v[52:55], v[168:171]
    v_cvt_pk_bf16_f32 v60, v40, v41
    s_add_u32 s12, s11, 4
    s_and_b32 s12, s12, 7
    s_lshl_b32 s12, s12, 14
    v_add_u32 v3, s12, v2
    v_mfma_f32_16x16x32_bf16 v[172:175], a[140:143], v[52:55], v[172:175]
    global_load_dwordx4 a[64:67], v3, s[44:45] offset:-4096 sc1
    v_mfma_f32_16x16x32_bf16 v[176:179], a[144:147], v[52:55], v[176:179]
    v_exp_f32 v42, v42
    v_mfma_f32_16x16x32_bf16 v[180:183], a[148:151], v[52:55], v[180:183]
    v_exp_f32 v43, v43
    v_mfma_f32_16x16x32_bf16 v[184:187], a[152:155], v[52:55], v[184:187]
    v_cvt_pk_bf16_f32 v61, v42, v43
    v_mfma_f32_16x16x32_bf16 v[188:191], a[156:159], v[52:55], v[188:191]
    global_load_dwordx4 a[68:71], v3, s[44:45] offset:-3072 sc1
    v_mfma_f32_16x16x32_bf16 a[196:199], a[208:211], v[52:55], a[196:199]
    v_exp_f32 v44, v44
    s_waitcnt vmcnt(10)
    v_mfma_f32_16x16x32_bf16 v[16:19], a[96:99], a[0:3], v[64:67]
    v_exp_f32 v45, v45
    v_mfma_f32_16x16x32_bf16 v[16:19], a[100:103], a[4:7], v[16:19]
    v_cvt_pk_bf16_f32 v62, v44, v45
    v_mfma_f32_16x16x32_bf16 v[16:19], a[104:107], a[8:11], v[16:19]
    global_load_dwordx4 a[72:75], v3, s[44:45] offset:-2048 sc1
    v_mfma_f32_16x16x32_bf16 v[16:19], a[108:111], a[12:15], v[16:19]
    v_exp_f32 v46, v46
    v_mfma_f32_16x16x32_bf16 v[20:23], a[112:115], a[0:3], v[64:67]
    v_exp_f32 v47, v47
    v_mfma_f32_16x16x32_bf16 v[20:23], a[116:119], a[4:7], v[20:23]
    v_cvt_pk_bf16_f32 v63, v46, v47
    v_mfma_f32_16x16x32_bf16 v[20:23], a[120:123], a[8:11], v[20:23]
    global_load_dwordx4 a[76:79], v3, s[44:45] offset:-1024 sc1
    v_mfma_f32_16x16x32_bf16 v[20:23], a[124:127], a[12:15], v[20:23]
    v_mfma_f32_16x16x32_bf16 v[24:27], a[96:99], a[16:19], v[68:71]
    v_exp_f32 v16, v16
    v_mfma_f32_16x16x32_bf16 v[24:27], a[100:103], a[20:23], v[24:27]
    v_exp_f32 v17, v17
    v_mfma_f32_16x16x32_bf16 v[24:27], a[104:107], a[24:27], v[24:27]
    v_cvt_pk_bf16_f32 v48, v16, v17
    v_mfma_f32_16x16x32_bf16 v[24:27], a[108:111], a[28:31], v[24:27]
    global_load_dwordx4 a[80:83], v3, s[44:45] offset:0 sc1
    v_mfma_f32_16x16x32_bf16 v[28:31], a[112:115], a[16:19], v[68:71]
    v_exp_f32 v18, v18
    v_mfma_f32_16x16x32_bf16 v[28:31], a[116:119], a[20:23], v[28:31]
    v_exp_f32 v19, v19
    v_mfma_f32_16x16x32_bf16 v[28:31], a[120:123], a[24:27], v[28:31]
    v_cvt_pk_bf16_f32 v49, v18, v19
    v_mfma_f32_16x16x32_bf16 v[28:31], a[124:127], a[28:31], v[28:31]
    global_load_dwordx4 a[84:87], v3, s[44:45] offset:1024 sc1
    v_mfma_f32_16x16x32_bf16 v[192:195], a[128:131], v[56:59], v[192:195]
    v_exp_f32 v20, v20
    v_mfma_f32_16x16x32_bf16 v[196:199], a[132:135], v[56:59], v[196:199]
    v_exp_f32 v21, v21
    v_mfma_f32_16x16x32_bf16 v[200:203], a[136:139], v[56:59], v[200:203]
    v_cvt_pk_bf16_f32 v50, v20, v21
    v_mfma_f32_16x16x32_bf16 v[204:207], a[140:143], v[56:59], v[204:207]
    global_load_dwordx4 a[88:91], v3, s[44:45] offset:2048 sc1
    v_mfma_f32_16x16x32_bf16 v[208:211], a[144:147], v[56:59], v[208:211]
    v_exp_f32 v22, v22
    v_mfma_f32_16x16x32_bf16 v[212:215], a[148:151], v[56:59], v[212:215]
    v_exp_f32 v23, v23
    v_mfma_f32_16x16x32_bf16 v[216:219], a[152:155], v[56:59], v[216:219]
    v_cvt_pk_bf16_f32 v51, v22, v23
    v_mfma_f32_16x16x32_bf16 v[220:223], a[156:159], v[56:59], v[220:223]
    global_load_dwordx4 a[92:95], v3, s[44:45] offset:3072 sc1
    v_mfma_f32_16x16x32_bf16 a[200:203], a[208:211], v[56:59], a[200:203]
    v_mfma_f32_16x16x32_bf16 v[224:227], a[128:131], v[60:63], v[224:227]
    v_exp_f32 v24, v24
    v_mfma_f32_16x16x32_bf16 v[228:231], a[132:135], v[60:63], v[228:231]
    v_exp_f32 v25, v25
    v_mfma_f32_16x16x32_bf16 v[232:235], a[136:139], v[60:63], v[232:235]
    v_cvt_pk_bf16_f32 v52, v24, v25
    v_mfma_f32_16x16x32_bf16 v[236:239], a[140:143], v[60:63], v[236:239]
    global_load_dwordx4 a[128:131], v3, s[46:47] offset:-4096 sc1
    v_mfma_f32_16x16x32_bf16 v[240:243], a[144:147], v[60:63], v[240:243]
    v_exp_f32 v26, v26
    v_mfma_f32_16x16x32_bf16 v[244:247], a[148:151], v[60:63], v[244:247]
    v_exp_f32 v27, v27
    v_mfma_f32_16x16x32_bf16 v[248:251], a[152:155], v[60:63], v[248:251]
    v_cvt_pk_bf16_f32 v53, v26, v27
    v_mfma_f32_16x16x32_bf16 v[252:255], a[156:159], v[60:63], v[252:255]
    global_load_dwordx4 a[132:135], v3, s[46:47] offset:-3072 sc1
    v_mfma_f32_16x16x32_bf16 a[204:207], a[208:211], v[60:63], a[204:207]
    v_exp_f32 v28, v28
    v_mfma_f32_16x16x32_bf16 v[32:35], a[96:99], a[32:35], v[72:75]
    v_exp_f32 v29, v29
    v_mfma_f32_16x16x32_bf16 v[32:35], a[100:103], a[36:39], v[32:35]
    v_cvt_pk_bf16_f32 v54, v28, v29
    v_mfma_f32_16x16x32_bf16 v[32:35], a[104:107], a[40:43], v[32:35]
    global_load_dwordx4 a[136:139], v3, s[46:47] offset:-2048 sc1
    v_mfma_f32_16x16x32_bf16 v[32:35], a[108:111], a[44:47], v[32:35]
    v_exp_f32 v30, v30
    v_mfma_f32_16x16x32_bf16 v[36:39], a[112:115], a[32:35], v[72:75]
    v_exp_f32 v31, v31
    v_mfma_f32_16x16x32_bf16 v[36:39], a[116:119], a[36:39], v[36:39]
    v_cvt_pk_bf16_f32 v55, v30, v31
    v_mfma_f32_16x16x32_bf16 v[36:39], a[120:123], a[40:43], v[36:39]
    global_load_dwordx4 a[140:143], v3, s[46:47] offset:-1024 sc1
    v_mfma_f32_16x16x32_bf16 v[36:39], a[124:127], a[44:47], v[36:39]
    v_mfma_f32_16x16x32_bf16 v[40:43], a[96:99], a[48:51], v[76:79]
    v_exp_f32 v32, v32
    v_mfma_f32_16x16x32_bf16 v[40:43], a[100:103], a[52:55], v[40:43]
    v_exp_f32 v33, v33
    v_mfma_f32_16x16x32_bf16 v[40:43], a[104:107], a[56:59], v[40:43]
    v_cvt_pk_bf16_f32 v56, v32, v33
    v_mfma_f32_16x16x32_bf16 v[40:43], a[108:111], a[60:63], v[40:43]
    global_load_dwordx4 a[144:147], v3, s[46:47] offset:0 sc1
    v_mfma_f32_16x16x32_bf16 v[44:47], a[112:115], a[48:51], v[76:79]
    v_exp_f32 v34, v34
    v_mfma_f32_16x16x32_bf16 v[44:47], a[116:119], a[52:55], v[44:47]
    v_exp_f32 v35, v35
    v_mfma_f32_16x16x32_bf16 v[44:47], a[120:123], a[56:59], v[44:47]
    v_cvt_pk_bf16_f32 v57, v34, v35
    v_mfma_f32_16x16x32_bf16 v[44:47], a[124:127], a[60:63], v[44:47]
    global_load_dwordx4 a[148:151], v3, s[46:47] offset:1024 sc1
    s_waitcnt vmcnt(14)
    v_mfma_f32_16x16x32_bf16 v[128:131], a[160:163], v[48:51], v[128:131]
    v_exp_f32 v36, v36
    v_mfma_f32_16x16x32_bf16 v[132:135], a[164:167], v[48:51], v[132:135]
    v_exp_f32 v37, v37
    v_mfma_f32_16x16x32_bf16 v[136:139], a[168:171], v[48:51], v[136:139]
    v_cvt_pk_bf16_f32 v58, v36, v37
    v_mfma_f32_16x16x32_bf16 v[140:143], a[172:175], v[48:51], v[140:143]
    global_load_dwordx4 a[152:155], v3, s[46:47] offset:2048 sc1
    v_mfma_f32_16x16x32_bf16 v[144:147], a[176:179], v[48:51], v[144:147]
    v_exp_f32 v38, v38
    v_mfma_f32_16x16x32_bf16 v[148:151], a[180:183], v[48:51], v[148:151]
    v_exp_f32 v39, v39
    v_mfma_f32_16x16x32_bf16 v[152:155], a[184:187], v[48:51], v[152:155]
    v_cvt_pk_bf16_f32 v59, v38, v39
    v_mfma_f32_16x16x32_bf16 v[156:159], a[188:191], v[48:51], v[156:159]
    global_load_dwordx4 a[156:159], v3, s[46:47] offset:3072 sc1
    v_mfma_f32_16x16x32_bf16 a[192:195], a[208:211], v[48:51], a[192:195]
    v_mfma_f32_16x16x32_bf16 v[160:163], a[160:163], v[52:55], v[160:163]
    v_exp_f32 v40, v40
    v_mfma_f32_16x16x32_bf16 v[164:167], a[164:167], v[52:55], v[164:167]
    v_exp_f32 v41, v41
    v_mfma_f32_16x16x32_bf16 v[168:171], a[168:171], v[52:55], v[168:171]
    v_cvt_pk_bf16_f32 v60, v40, v41
    s_add_u32 s12, s11, 5
    s_and_b32 s12, s12, 7
    s_lshl_b32 s12, s12, 14
    v_add_u32 v3, s12, v2
    v_mfma_f32_16x16x32_bf16 v[172:175], a[172:175], v[52:55], v[172:175]
    global_load_dwordx4 a[96:99], v3, s[44:45] offset:-4096 sc1
    v_mfma_f32_16x16x32_bf16 v[176:179], a[176:179], v[52:55], v[176:179]
    v_exp_f32 v42, v42
    v_mfma_f32_16x16x32_bf16 v[180:183], a[180:183], v[52:55], v[180:183]
    v_exp_f32 v43, v43
    v_mfma_f32_16x16x32_bf16 v[184:187], a[184:187], v[52:55], v[184:187]
    v_cvt_pk_bf16_f32 v61, v42, v43
    v_mfma_f32_16x16x32_bf16 v[188:191], a[188:191], v[52:55], v[188:191]
    global_load_dwordx4 a[100:103], v3, s[44:45] offset:-3072 sc1
    v_mfma_f32_16x16x32_bf16 a[196:199], a[208:211], v[52:55], a[196:199]
    v_exp_f32 v44, v44
    s_waitcnt vmcnt(10)
    v_mfma_f32_16x16x32_bf16 v[16:19], a[64:67], a[0:3], v[64:67]
    v_exp_f32 v45, v45
    v_mfma_f32_16x16x32_bf16 v[16:19], a[68:71], a[4:7], v[16:19]
    v_cvt_pk_bf16_f32 v62, v44, v45
    v_mfma_f32_16x16x32_bf16 v[16:19], a[72:75], a[8:11], v[16:19]
    global_load_dwordx4 a[104:107], v3, s[44:45] offset:-2048 sc1
    v_mfma_f32_16x16x32_bf16 v[16:19], a[76:79], a[12:15], v[16:19]
    v_exp_f32 v46, v46
    v_mfma_f32_16x16x32_bf16 v[20:23], a[80:83], a[0:3], v[64:67]
    v_exp_f32 v47, v47
    v_mfma_f32_16x16x32_bf16 v[20:23], a[84:87], a[4:7], v[20:23]
    v_cvt_pk_bf16_f32 v63, v46, v47
    v_mfma_f32_16x16x32_bf16 v[20:23], a[88:91], a[8:11], v[20:23]
    global_load_dwordx4 a[108:111], v3, s[44:45] offset:-1024 sc1
    v_mfma_f32_16x16x32_bf16 v[20:23], a[92:95], a[12:15], v[20:23]
    v_mfma_f32_16x16x32_bf16 v[24:27], a[64:67], a[16:19], v[68:71]
    v_exp_f32 v16, v16
    v_mfma_f32_16x16x32_bf16 v[24:27], a[68:71], a[20:23], v[24:27]
    v_exp_f32 v17, v17
    v_mfma_f32_16x16x32_bf16 v[24:27], a[72:75], a[24:27], v[24:27]
    v_cvt_pk_bf16_f32 v48, v16, v17
    v_mfma_f32_16x16x32_bf16 v[24:27], a[76:79], a[28:31], v[24:27]
    global_load_dwordx4 a[112:115], v3, s[44:45] offset:0 sc1
    v_mfma_f32_16x16x32_bf16 v[28:31], a[80:83], a[16:19], v[68:71]
    v_exp_f32 v18, v18
    v_mfma_f32_16x16x32_bf16 v[28:31], a[84:87], a[20:23], v[28:31]
    v_exp_f32 v19, v19
    v_mfma_f32_16x16x32_bf16 v[28:31], a[88:91], a[24:27], v[28:31]
    v_cvt_pk_bf16_f32 v49, v18, v19
    v_mfma_f32_16x16x32_bf16 v[28:31], a[92:95], a[28:31], v[28:31]
    global_load_dwordx4 a[116:119], v3, s[44:45] offset:1024 sc1
    v_mfma_f32_16x16x32_bf16 v[192:195], a[160:163], v[56:59], v[192:195]
    v_exp_f32 v20, v20
    v_mfma_f32_16x16x32_bf16 v[196:199], a[164:167], v[56:59], v[196:199]
    v_exp_f32 v21, v21
    v_mfma_f32_16x16x32_bf16 v[200:203], a[168:171], v[56:59], v[200:203]
    v_cvt_pk_bf16_f32 v50, v20, v21
    v_mfma_f32_16x16x32_bf16 v[204:207], a[172:175], v[56:59], v[204:207]
    global_load_dwordx4 a[120:123], v3, s[44:45] offset:2048 sc1
    v_mfma_f32_16x16x32_bf16 v[208:211], a[176:179], v[56:59], v[208:211]
    v_exp_f32 v22, v22
    v_mfma_f32_16x16x32_bf16 v[212:215], a[180:183], v[56:59], v[212:215]
    v_exp_f32 v23, v23
    v_mfma_f32_16x16x32_bf16 v[216:219], a[184:187], v[56:59], v[216:219]
    v_cvt_pk_bf16_f32 v51, v22, v23
    v_mfma_f32_16x16x32_bf16 v[220:223], a[188:191], v[56:59], v[220:223]
    global_load_dwordx4 a[124:127], v3, s[44:45] offset:3072 sc1
    v_mfma_f32_16x16x32_bf16 a[200:203], a[208:211], v[56:59], a[200:203]
    v_mfma_f32_16x16x32_bf16 v[224:227], a[160:163], v[60:63], v[224:227]
    v_exp_f32 v24, v24
    v_mfma_f32_16x16x32_bf16 v[228:231], a[164:167], v[60:63], v[228:231]
    v_exp_f32 v25, v25
    v_mfma_f32_16x16x32_bf16 v[232:235], a[168:171], v[60:63], v[232:235]
    v_cvt_pk_bf16_f32 v52, v24, v25
    v_mfma_f32_16x16x32_bf16 v[236:239], a[172:175], v[60:63], v[236:239]
    global_load_dwordx4 a[160:163], v3, s[46:47] offset:-4096 sc1
    v_mfma_f32_16x16x32_bf16 v[240:243], a[176:179], v[60:63], v[240:243]
    v_exp_f32 v26, v26
    v_mfma_f32_16x16x32_bf16 v[244:247], a[180:183], v[60:63], v[244:247]
    v_exp_f32 v27, v27
    v_mfma_f32_16x16x32_bf16 v[248:251], a[184:187], v[60:63], v[248:251]
    v_cvt_pk_bf16_f32 v53, v26, v27
    v_mfma_f32_16x16x32_bf16 v[252:255], a[188:191], v[60:63], v[252:255]
    global_load_dwordx4 a[164:167], v3, s[46:47] offset:-3072 sc1
    v_mfma_f32_16x16x32_bf16 a[204:207], a[208:211], v[60:63], a[204:207]
    v_exp_f32 v28, v28
    v_mfma_f32_16x16x32_bf16 v[32:35], a[64:67], a[32:35], v[72:75]
    v_exp_f32 v29, v29
    v_mfma_f32_16x16x32_bf16 v[32:35], a[68:71], a[36:39], v[32:35]
    v_cvt_pk_bf16_f32 v54, v28, v29
    v_mfma_f32_16x16x32_bf16 v[32:35], a[72:75], a[40:43], v[32:35]
    global_load_dwordx4 a[168:171], v3, s[46:47] offset:-2048 sc1
    v_mfma_f32_16x16x32_bf16 v[32:35], a[76:79], a[44:47], v[32:35]
    v_exp_f32 v30, v30
    v_mfma_f32_16x16x32_bf16 v[36:39], a[80:83], a[32:35], v[72:75]
    v_exp_f32 v31, v31
    v_mfma_f32_16x16x32_bf16 v[36:39], a[84:87], a[36:39], v[36:39]
    v_cvt_pk_bf16_f32 v55, v30, v31
    v_mfma_f32_16x16x32_bf16 v[36:39], a[88:91], a[40:43], v[36:39]
    global_load_dwordx4 a[172:175], v3, s[46:47] offset:-1024 sc1
    v_mfma_f32_16x16x32_bf16 v[36:39], a[92:95], a[44:47], v[36:39]
    v_mfma_f32_16x16x32_bf16 v[40:43], a[64:67], a[48:51], v[76:79]
    v_exp_f32 v32, v32
    v_mfma_f32_16x16x32_bf16 v[40:43], a[68:71], a[52:55], v[40:43]
    v_exp_f32 v33, v33
    v_mfma_f32_16x16x32_bf16 v[40:43], a[72:75], a[56:59], v[40:43]
    v_cvt_pk_bf16_f32 v56, v32, v33
    v_mfma_f32_16x16x32_bf16 v[40:43], a[76:79], a[60:63], v[40:43]
    global_load_dwordx4 a[176:179], v3, s[46:47] offset:0 sc1
    v_mfma_f32_16x16x32_bf16 v[44:47], a[80:83], a[48:51], v[76:79]
    v_exp_f32 v34, v34
    v_mfma_f32_16x16x32_bf16 v[44:47], a[84:87], a[52:55], v[44:47]
    v_exp_f32 v35, v35
    v_mfma_f32_16x16x32_bf16 v[44:47], a[88:91], a[56:59], v[44:47]
    v_cvt_pk_bf16_f32 v57, v34, v35
    v_mfma_f32_16x16x32_bf16 v[44:47], a[92:95], a[60:63], v[44:47]
    global_load_dwordx4 a[180:183], v3, s[46:47] offset:1024 sc1
    s_waitcnt vmcnt(14)
    v_mfma_f32_16x16x32_bf16 v[128:131], a[128:131], v[48:51], v[128:131]
    v_exp_f32 v36, v36
    v_mfma_f32_16x16x32_bf16 v[132:135], a[132:135], v[48:51], v[132:135]
    v_exp_f32 v37, v37
    v_mfma_f32_16x16x32_bf16 v[136:139], a[136:139], v[48:51], v[136:139]
    v_cvt_pk_bf16_f32 v58, v36, v37
    v_mfma_f32_16x16x32_bf16 v[140:143], a[140:143], v[48:51], v[140:143]
    global_load_dwordx4 a[184:187], v3, s[46:47] offset:2048 sc1
    v_mfma_f32_16x16x32_bf16 v[144:147], a[144:147], v[48:51], v[144:147]
    v_exp_f32 v38, v38
    v_mfma_f32_16x16x32_bf16 v[148:151], a[148:151], v[48:51], v[148:151]
    v_exp_f32 v39, v39
    v_mfma_f32_16x16x32_bf16 v[152:155], a[152:155], v[48:51], v[152:155]
    v_cvt_pk_bf16_f32 v59, v38, v39
    v_mfma_f32_16x16x32_bf16 v[156:159], a[156:159], v[48:51], v[156:159]
    global_load_dwordx4 a[188:191], v3, s[46:47] offset:3072 sc1
    v_mfma_f32_16x16x32_bf16 a[192:195], a[208:211], v[48:51], a[192:195]
    v_mfma_f32_16x16x32_bf16 v[160:163], a[128:131], v[52:55], v[160:163]
    v_exp_f32 v40, v40
    v_mfma_f32_16x16x32_bf16 v[164:167], a[132:135], v[52:55], v[164:167]
    v_exp_f32 v41, v41
    v_mfma_f32_16x16x32_bf16 v[168:171], a[136:139], v[52:55], v[168:171]
    v_cvt_pk_bf16_f32 v60, v40, v41
    s_add_u32 s12, s11, 6
    s_and_b32 s12, s12, 7
    s_lshl_b32 s12, s12, 14
    v_add_u32 v3, s12, v2
    v_mfma_f32_16x16x32_bf16 v[172:175], a[140:143], v[52:55], v[172:175]
    global_load_dwordx4 a[64:67], v3, s[44:45] offset:-4096 sc1
    v_mfma_f32_16x16x32_bf16 v[176:179], a[144:147], v[52:55], v[176:179]
    v_exp_f32 v42, v42
    v_mfma_f32_16x16x32_bf16 v[180:183], a[148:151], v[52:55], v[180:183]
    v_exp_f32 v43, v43
    v_mfma_f32_16x16x32_bf16 v[184:187], a[152:155], v[52:55], v[184:187]
    v_cvt_pk_bf16_f32 v61, v42, v43
    v_mfma_f32_16x16x32_bf16 v[188:191], a[156:159], v[52:55], v[188:191]
    global_load_dwordx4 a[68:71], v3, s[44:45] offset:-3072 sc1
    v_mfma_f32_16x16x32_bf16 a[196:199], a[208:211], v[52:55], a[196:199]
    v_exp_f32 v44, v44
    s_waitcnt vmcnt(10)
    v_mfma_f32_16x16x32_bf16 v[16:19], a[96:99], a[0:3], v[64:67]
    v_exp_f32 v45, v45
    v_mfma_f32_16x16x32_bf16 v[16:19], a[100:103], a[4:7], v[16:19]
    v_cvt_pk_bf16_f32 v62, v44, v45
    v_mfma_f32_16x16x32_bf16 v[16:19], a[104:107], a[8:11], v[16:19]
    global_load_dwordx4 a[72:75], v3, s[44:45] offset:-2048 sc1
    v_mfma_f32_16x16x32_bf16 v[16:19], a[108:111], a[12:15], v[16:19]
    v_exp_f32 v46, v46
    v_mfma_f32_16x16x32_bf16 v[20:23], a[112:115], a[0:3], v[64:67]
    v_exp_f32 v47, v47
    v_mfma_f32_16x16x32_bf16 v[20:23], a[116:119], a[4:7], v[20:23]
    v_cvt_pk_bf16_f32 v63, v46, v47
    v_mfma_f32_16x16x32_bf16 v[20:23], a[120:123], a[8:11], v[20:23]
    global_load_dwordx4 a[76:79], v3, s[44:45] offset:-1024 sc1
    v_mfma_f32_16x16x32_bf16 v[20:23], a[124:127], a[12:15], v[20:23]
    v_mfma_f32_16x16x32_bf16 v[24:27], a[96:99], a[16:19], v[68:71]
    v_exp_f32 v16, v16
    v_mfma_f32_16x16x32_bf16 v[24:27], a[100:103], a[20:23], v[24:27]
    v_exp_f32 v17, v17
    v_mfma_f32_16x16x32_bf16 v[24:27], a[104:107], a[24:27], v[24:27]
    v_cvt_pk_bf16_f32 v48, v16, v17
    v_mfma_f32_16x16x32_bf16 v[24:27], a[108:111], a[28:31], v[24:27]
    global_load_dwordx4 a[80:83], v3, s[44:45] offset:0 sc1
    v_mfma_f32_16x16x32_bf16 v[28:31], a[112:115], a[16:19], v[68:71]
    v_exp_f32 v18, v18
    v_mfma_f32_16x16x32_bf16 v[28:31], a[116:119], a[20:23], v[28:31]
    v_exp_f32 v19, v19
    v_mfma_f32_16x16x32_bf16 v[28:31], a[120:123], a[24:27], v[28:31]
    v_cvt_pk_bf16_f32 v49, v18, v19
    v_mfma_f32_16x16x32_bf16 v[28:31], a[124:127], a[28:31], v[28:31]
    global_load_dwordx4 a[84:87], v3, s[44:45] offset:1024 sc1
    v_mfma_f32_16x16x32_bf16 v[192:195], a[128:131], v[56:59], v[192:195]
    v_exp_f32 v20, v20
    v_mfma_f32_16x16x32_bf16 v[196:199], a[132:135], v[56:59], v[196:199]
    v_exp_f32 v21, v21
    v_mfma_f32_16x16x32_bf16 v[200:203], a[136:139], v[56:59], v[200:203]
    v_cvt_pk_bf16_f32 v50, v20, v21
    v_mfma_f32_16x16x32_bf16 v[204:207], a[140:143], v[56:59], v[204:207]
    global_load_dwordx4 a[88:91], v3, s[44:45] offset:2048 sc1
    v_mfma_f32_16x16x32_bf16 v[208:211], a[144:147], v[56:59], v[208:211]
    v_exp_f32 v22, v22
    v_mfma_f32_16x16x32_bf16 v[212:215], a[148:151], v[56:59], v[212:215]
    v_exp_f32 v23, v23
    v_mfma_f32_16x16x32_bf16 v[216:219], a[152:155], v[56:59], v[216:219]
    v_cvt_pk_bf16_f32 v51, v22, v23
    v_mfma_f32_16x16x32_bf16 v[220:223], a[156:159], v[56:59], v[220:223]
    global_load_dwordx4 a[92:95], v3, s[44:45] offset:3072 sc1
    v_mfma_f32_16x16x32_bf16 a[200:203], a[208:211], v[56:59], a[200:203]
    v_mfma_f32_16x16x32_bf16 v[224:227], a[128:131], v[60:63], v[224:227]
    v_exp_f32 v24, v24
    v_mfma_f32_16x16x32_bf16 v[228:231], a[132:135], v[60:63], v[228:231]
    v_exp_f32 v25, v25
    v_mfma_f32_16x16x32_bf16 v[232:235], a[136:139], v[60:63], v[232:235]
    v_cvt_pk_bf16_f32 v52, v24, v25
    v_mfma_f32_16x16x32_bf16 v[236:239], a[140:143], v[60:63], v[236:239]
    global_load_dwordx4 a[128:131], v3, s[46:47] offset:-4096 sc1
    v_mfma_f32_16x16x32_bf16 v[240:243], a[144:147], v[60:63], v[240:243]
    v_exp_f32 v26, v26
    v_mfma_f32_16x16x32_bf16 v[244:247], a[148:151], v[60:63], v[244:247]
    v_exp_f32 v27, v27
    global_load_dword v125, v7, s[48:49] sc1
    v_mfma_f32_16x16x32_bf16 v[248:251], a[152:155], v[60:63], v[248:251]
    v_cvt_pk_bf16_f32 v53, v26, v27
    v_mfma_f32_16x16x32_bf16 v[252:255], a[156:159], v[60:63], v[252:255]
    global_load_dwordx4 a[132:135], v3, s[46:47] offset:-3072 sc1
    v_mfma_f32_16x16x32_bf16 a[204:207], a[208:211], v[60:63], a[204:207]
    v_exp_f32 v28, v28
    v_mfma_f32_16x16x32_bf16 v[32:35], a[96:99], a[32:35], v[72:75]
    v_exp_f32 v29, v29
    v_mfma_f32_16x16x32_bf16 v[32:35], a[100:103], a[36:39], v[32:35]
    v_cvt_pk_bf16_f32 v54, v28, v29
    v_mfma_f32_16x16x32_bf16 v[32:35], a[104:107], a[40:43], v[32:35]
    global_load_dwordx4 a[136:139], v3, s[46:47] offset:-2048 sc1
    v_mfma_f32_16x16x32_bf16 v[32:35], a[108:111], a[44:47], v[32:35]
    v_exp_f32 v30, v30
    v_mfma_f32_16x16x32_bf16 v[36:39], a[112:115], a[32:35], v[72:75]
    v_exp_f32 v31, v31
    v_mfma_f32_16x16x32_bf16 v[36:39], a[116:119], a[36:39], v[36:39]
    v_cvt_pk_bf16_f32 v55, v30, v31
    v_mfma_f32_16x16x32_bf16 v[36:39], a[120:123], a[40:43], v[36:39]
    global_load_dwordx4 a[140:143], v3, s[46:47] offset:-1024 sc1
    v_mfma_f32_16x16x32_bf16 v[36:39], a[124:127], a[44:47], v[36:39]
    v_mfma_f32_16x16x32_bf16 v[40:43], a[96:99], a[48:51], v[76:79]
    v_exp_f32 v32, v32
    v_mfma_f32_16x16x32_bf16 v[40:43], a[100:103], a[52:55], v[40:43]
    v_exp_f32 v33, v33
    v_mfma_f32_16x16x32_bf16 v[40:43], a[104:107], a[56:59], v[40:43]
    v_cvt_pk_bf16_f32 v56, v32, v33
    v_mfma_f32_16x16x32_bf16 v[40:43], a[108:111], a[60:63], v[40:43]
    global_load_dwordx4 a[144:147], v3, s[46:47] offset:0 sc1
    v_mfma_f32_16x16x32_bf16 v[44:47], a[112:115], a[48:51], v[76:79]
    v_exp_f32 v34, v34
    v_mfma_f32_16x16x32_bf16 v[44:47], a[116:119], a[52:55], v[44:47]
    v_exp_f32 v35, v35
    v_mfma_f32_16x16x32_bf16 v[44:47], a[120:123], a[56:59], v[44:47]
    v_cvt_pk_bf16_f32 v57, v34, v35
    v_mfma_f32_16x16x32_bf16 v[44:47], a[124:127], a[60:63], v[44:47]
    global_load_dwordx4 a[148:151], v3, s[46:47] offset:1024 sc1
    s_waitcnt vmcnt(15)
    v_mfma_f32_16x16x32_bf16 v[128:131], a[160:163], v[48:51], v[128:131]
    v_exp_f32 v36, v36
    v_mfma_f32_16x16x32_bf16 v[132:135], a[164:167], v[48:51], v[132:135]
    v_exp_f32 v37, v37
    v_mfma_f32_16x16x32_bf16 v[136:139], a[168:171], v[48:51], v[136:139]
    v_cvt_pk_bf16_f32 v58, v36, v37
    v_mfma_f32_16x16x32_bf16 v[140:143], a[172:175], v[48:51], v[140:143]
    global_load_dwordx4 a[152:155], v3, s[46:47] offset:2048 sc1
    v_mfma_f32_16x16x32_bf16 v[144:147], a[176:179], v[48:51], v[144:147]
    v_exp_f32 v38, v38
    v_mfma_f32_16x16x32_bf16 v[148:151], a[180:183], v[48:51], v[148:151]
    v_exp_f32 v39, v39
    v_mfma_f32_16x16x32_bf16 v[152:155], a[184:187], v[48:51], v[152:155]
    v_cvt_pk_bf16_f32 v59, v38, v39
    v_mfma_f32_16x16x32_bf16 v[156:159], a[188:191], v[48:51], v[156:159]
    global_load_dwordx4 a[156:159], v3, s[46:47] offset:3072 sc1
    v_mfma_f32_16x16x32_bf16 a[192:195], a[208:211], v[48:51], a[192:195]
    v_mfma_f32_16x16x32_bf16 v[160:163], a[160:163], v[52:55], v[160:163]
    v_exp_f32 v40, v40
    v_mfma_f32_16x16x32_bf16 v[164:167], a[164:167], v[52:55], v[164:167]
    v_exp_f32 v41, v41
    v_mfma_f32_16x16x32_bf16 v[168:171], a[168:171], v[52:55], v[168:171]
    v_cvt_pk_bf16_f32 v60, v40, v41
    s_add_u32 s12, s11, 7
    s_and_b32 s12, s12, 7
    s_lshl_b32 s12, s12, 14
    v_add_u32 v3, s12, v2
    v_mfma_f32_16x16x32_bf16 v[172:175], a[172:175], v[52:55], v[172:175]
    global_load_dwordx4 a[96:99], v3, s[44:45] offset:-4096 sc1
    v_mfma_f32_16x16x32_bf16 v[176:179], a[176:179], v[52:55], v[176:179]
    v_exp_f32 v42, v42
    v_mfma_f32_16x16x32_bf16 v[180:183], a[180:183], v[52:55], v[180:183]
    v_exp_f32 v43, v43
    v_mfma_f32_16x16x32_bf16 v[184:187], a[184:187], v[52:55], v[184:187]
    v_cvt_pk_bf16_f32 v61, v42, v43
    v_mfma_f32_16x16x32_bf16 v[188:191], a[188:191], v[52:55], v[188:191]
    global_load_dwordx4 a[100:103], v3, s[44:45] offset:-3072 sc1
    v_mfma_f32_16x16x32_bf16 a[196:199], a[208:211], v[52:55], a[196:199]
    v_exp_f32 v44, v44
    s_waitcnt vmcnt(11)
    v_mfma_f32_16x16x32_bf16 v[16:19], a[64:67], a[0:3], v[64:67]
    v_exp_f32 v45, v45
    v_mfma_f32_16x16x32_bf16 v[16:19], a[68:71], a[4:7], v[16:19]
    v_cvt_pk_bf16_f32 v62, v44, v45
    v_mfma_f32_16x16x32_bf16 v[16:19], a[72:75], a[8:11], v[16:19]
    global_load_dwordx4 a[104:107], v3, s[44:45] offset:-2048 sc1
    v_mfma_f32_16x16x32_bf16 v[16:19], a[76:79], a[12:15], v[16:19]
    v_exp_f32 v46, v46
    v_mfma_f32_16x16x32_bf16 v[20:23], a[80:83], a[0:3], v[64:67]
    v_exp_f32 v47, v47
    v_mfma_f32_16x16x32_bf16 v[20:23], a[84:87], a[4:7], v[20:23]
    v_cvt_pk_bf16_f32 v63, v46, v47
    v_mfma_f32_16x16x32_bf16 v[20:23], a[88:91], a[8:11], v[20:23]
    global_load_dwordx4 a[108:111], v3, s[44:45] offset:-1024 sc1
    v_mfma_f32_16x16x32_bf16 v[20:23], a[92:95], a[12:15], v[20:23]
    v_mfma_f32_16x16x32_bf16 v[24:27], a[64:67], a[16:19], v[68:71]
    v_exp_f32 v16, v16
    v_mfma_f32_16x16x32_bf16 v[24:27], a[68:71], a[20:23], v[24:27]
    v_exp_f32 v17, v17
    v_mfma_f32_16x16x32_bf16 v[24:27], a[72:75], a[24:27], v[24:27]
    v_cvt_pk_bf16_f32 v48, v16, v17
    v_mfma_f32_16x16x32_bf16 v[24:27], a[76:79], a[28:31], v[24:27]
    global_load_dwordx4 a[112:115], v3, s[44:45] offset:0 sc1
    v_mfma_f32_16x16x32_bf16 v[28:31], a[80:83], a[16:19], v[68:71]
    v_exp_f32 v18, v18
    v_mfma_f32_16x16x32_bf16 v[28:31], a[84:87], a[20:23], v[28:31]
    v_exp_f32 v19, v19
    v_mfma_f32_16x16x32_bf16 v[28:31], a[88:91], a[24:27], v[28:31]
    v_cvt_pk_bf16_f32 v49, v18, v19
    v_mfma_f32_16x16x32_bf16 v[28:31], a[92:95], a[28:31], v[28:31]
    global_load_dwordx4 a[116:119], v3, s[44:45] offset:1024 sc1
    v_mfma_f32_16x16x32_bf16 v[192:195], a[160:163], v[56:59], v[192:195]
    v_exp_f32 v20, v20
    v_mfma_f32_16x16x32_bf16 v[196:199], a[164:167], v[56:59], v[196:199]
    v_exp_f32 v21, v21
    v_mfma_f32_16x16x32_bf16 v[200:203], a[168:171], v[56:59], v[200:203]
    v_cvt_pk_bf16_f32 v50, v20, v21
    v_mfma_f32_16x16x32_bf16 v[204:207], a[172:175], v[56:59], v[204:207]
    global_load_dwordx4 a[120:123], v3, s[44:45] offset:2048 sc1
    v_mfma_f32_16x16x32_bf16 v[208:211], a[176:179], v[56:59], v[208:211]
    v_exp_f32 v22, v22
    v_mfma_f32_16x16x32_bf16 v[212:215], a[180:183], v[56:59], v[212:215]
    v_exp_f32 v23, v23
    v_mfma_f32_16x16x32_bf16 v[216:219], a[184:187], v[56:59], v[216:219]
    v_cvt_pk_bf16_f32 v51, v22, v23
    v_mfma_f32_16x16x32_bf16 v[220:223], a[188:191], v[56:59], v[220:223]
    global_load_dwordx4 a[124:127], v3, s[44:45] offset:3072 sc1
    v_mfma_f32_16x16x32_bf16 a[200:203], a[208:211], v[56:59], a[200:203]
    v_mfma_f32_16x16x32_bf16 v[224:227], a[160:163], v[60:63], v[224:227]
    v_exp_f32 v24, v24
    v_mfma_f32_16x16x32_bf16 v[228:231], a[164:167], v[60:63], v[228:231]
    v_exp_f32 v25, v25
    v_mfma_f32_16x16x32_bf16 v[232:235], a[168:171], v[60:63], v[232:235]
    v_cvt_pk_bf16_f32 v52, v24, v25
    v_mfma_f32_16x16x32_bf16 v[236:239], a[172:175], v[60:63], v[236:239]
    global_load_dwordx4 a[160:163], v3, s[46:47] offset:-4096 sc1
    v_mfma_f32_16x16x32_bf16 v[240:243], a[176:179], v[60:63], v[240:243]
    v_exp_f32 v26, v26
    v_mfma_f32_16x16x32_bf16 v[244:247], a[180:183], v[60:63], v[244:247]
    v_exp_f32 v27, v27
    v_mfma_f32_16x16x32_bf16 v[248:251], a[184:187], v[60:63], v[248:251]
    v_cvt_pk_bf16_f32 v53, v26, v27
    v_mfma_f32_16x16x32_bf16 v[252:255], a[188:191], v[60:63], v[252:255]
    global_load_dwordx4 a[164:167], v3, s[46:47] offset:-3072 sc1
    v_mfma_f32_16x16x32_bf16 a[204:207], a[208:211], v[60:63], a[204:207]
    v_exp_f32 v28, v28
    v_mfma_f32_16x16x32_bf16 v[32:35], a[64:67], a[32:35], v[72:75]
    v_exp_f32 v29, v29
    v_mfma_f32_16x16x32_bf16 v[32:35], a[68:71], a[36:39], v[32:35]
    v_cvt_pk_bf16_f32 v54, v28, v29
    v_mfma_f32_16x16x32_bf16 v[32:35], a[72:75], a[40:43], v[32:35]
    global_load_dwordx4 a[168:171], v3, s[46:47] offset:-2048 sc1
    v_mfma_f32_16x16x32_bf16 v[32:35], a[76:79], a[44:47], v[32:35]
    v_exp_f32 v30, v30
    v_mfma_f32_16x16x32_bf16 v[36:39], a[80:83], a[32:35], v[72:75]
    v_exp_f32 v31, v31
    v_mfma_f32_16x16x32_bf16 v[36:39], a[84:87], a[36:39], v[36:39]
    v_cvt_pk_bf16_f32 v55, v30, v31
    v_mfma_f32_16x16x32_bf16 v[36:39], a[88:91], a[40:43], v[36:39]
    global_load_dwordx4 a[172:175], v3, s[46:47] offset:-1024 sc1
    v_mfma_f32_16x16x32_bf16 v[36:39], a[92:95], a[44:47], v[36:39]
    v_mfma_f32_16x16x32_bf16 v[40:43], a[64:67], a[48:51], v[76:79]
    v_exp_f32 v32, v32
    v_mfma_f32_16x16x32_bf16 v[40:43], a[68:71], a[52:55], v[40:43]
    v_exp_f32 v33, v33
    v_mfma_f32_16x16x32_bf16 v[40:43], a[72:75], a[56:59], v[40:43]
    v_cvt_pk_bf16_f32 v56, v32, v33
    v_mfma_f32_16x16x32_bf16 v[40:43], a[76:79], a[60:63], v[40:43]
    global_load_dwordx4 a[176:179], v3, s[46:47] offset:0 sc1
    v_mfma_f32_16x16x32_bf16 v[44:47], a[80:83], a[48:51], v[76:79]
    v_exp_f32 v34, v34
    v_mfma_f32_16x16x32_bf16 v[44:47], a[84:87], a[52:55], v[44:47]
    v_exp_f32 v35, v35
    v_mfma_f32_16x16x32_bf16 v[44:47], a[88:91], a[56:59], v[44:47]
    v_cvt_pk_bf16_f32 v57, v34, v35
    v_mfma_f32_16x16x32_bf16 v[44:47], a[92:95], a[60:63], v[44:47]
    global_load_dwordx4 a[180:183], v3, s[46:47] offset:1024 sc1
    s_waitcnt vmcnt(14)
    v_mfma_f32_16x16x32_bf16 v[128:131], a[128:131], v[48:51], v[128:131]
    v_exp_f32 v36, v36
    v_mfma_f32_16x16x32_bf16 v[132:135], a[132:135], v[48:51], v[132:135]
    v_exp_f32 v37, v37
    v_mfma_f32_16x16x32_bf16 v[136:139], a[136:139], v[48:51], v[136:139]
    v_cvt_pk_bf16_f32 v58, v36, v37
    v_mfma_f32_16x16x32_bf16 v[140:143], a[140:143], v[48:51], v[140:143]
    global_load_dwordx4 a[184:187], v3, s[46:47] offset:2048 sc1
    v_mfma_f32_16x16x32_bf16 v[144:147], a[144:147], v[48:51], v[144:147]
    v_exp_f32 v38, v38
    v_mfma_f32_16x16x32_bf16 v[148:151], a[148:151], v[48:51], v[148:151]
    v_exp_f32 v39, v39
    v_mfma_f32_16x16x32_bf16 v[152:155], a[152:155], v[48:51], v[152:155]
    v_cvt_pk_bf16_f32 v59, v38, v39
    s_waitcnt vmcnt(22)
    v_cmp_le_u32 vcc, 16, v125
    s_mov_b32 s99, 0
    s_nop 0
    s_cmp_eq_u64 vcc, -1
    s_cbranch_scc1 L_chk_2_ok
L_chk_2_p:
    global_load_dword v125, v7, s[48:49] sc1
    s_waitcnt vmcnt(0)
    v_cmp_le_u32 vcc, 16, v125
    s_add_u32 s99, s99, 1
    s_cmp_eq_u64 vcc, -1
    s_cbranch_scc1 L_chk_2_ok
    s_cmp_lt_u32 s99, 0x40000
    s_cbranch_scc1 L_chk_2_p
L_chk_2_ok:
    v_mfma_f32_16x16x32_bf16 v[156:159], a[156:159], v[48:51], v[156:159]
    global_load_dwordx4 a[188:191], v3, s[46:47] offset:3072 sc1
    v_mfma_f32_16x16x32_bf16 a[192:195], a[208:211], v[48:51], a[192:195]
    v_mfma_f32_16x16x32_bf16 v[160:163], a[128:131], v[52:55], v[160:163]
    v_exp_f32 v40, v40
    v_mfma_f32_16x16x32_bf16 v[164:167], a[132:135], v[52:55], v[164:167]
    v_exp_f32 v41, v41
    v_mfma_f32_16x16x32_bf16 v[168:171], a[136:139], v[52:55], v[168:171]
    v_cvt_pk_bf16_f32 v60, v40, v41
    s_add_u32 s12, s11, 8
    s_and_b32 s12, s12, 7
    s_lshl_b32 s12, s12, 14
    v_add_u32 v3, s12, v1
    v_mfma_f32_16x16x32_bf16 v[172:175], a[140:143], v[52:55], v[172:175]
    global_load_dwordx4 a[64:67], v3, s[44:45] offset:-4096 sc1
    v_mfma_f32_16x16x32_bf16 v[176:179], a[144:147], v[52:55], v[176:179]
    v_exp_f32 v42, v42
    v_mfma_f32_16x16x32_bf16 v[180:183], a[148:151], v[52:55], v[180:183]
    v_exp_f32 v43, v43
    v_mfma_f32_16x16x32_bf16 v[184:187], a[152:155], v[52:55], v[184:187]
    v_cvt_pk_bf16_f32 v61, v42, v43
    v_mfma_f32_16x16x32_bf16 v[188:191], a[156:159], v[52:55], v[188:191]
    global_load_dwordx4 a[68:71], v3, s[44:45] offset:-3072 sc1
    v_mfma_f32_16x16x32_bf16 a[196:199], a[208:211], v[52:55], a[196:199]
    v_exp_f32 v44, v44
    s_add_u32 s12, s11, 8
    s_and_b32 s12, s12, 7
    s_lshl_b32 s12, s12, 14
    s_mov_b32 s51, 0
L_loop:
    s_waitcnt vmcnt(10)
    v_mfma_f32_16x16x32_bf16 v[16:19], a[96:99], a[0:3], v[64:67]
    v_exp_f32 v45, v45
    v_mfma_f32_16x16x32_bf16 v[16:19], a[100:103], a[4:7], v[16:19]
    v_cvt_pk_bf16_f32 v62, v44, v45
    v_mfma_f32_16x16x32_bf16 v[16:19], a[104:107], a[8:11], v[16:19]
    global_load_dwordx4 a[72:75], v3, s[44:45] offset:-2048 sc1
    v_mfma_f32_16x16x32_bf16 v[16:19], a[108:111], a[12:15], v[16:19]
    v_exp_f32 v46, v46
    v_mfma_f32_16x16x32_bf16 v[20:23], a[112:115], a[0:3], v[64:67]
    v_exp_f32 v47, v47
    v_mfma_f32_16x16x32_bf16 v[20:23], a[116:119], a[4:7], v[20:23]
    v_cvt_pk_bf16_f32 v63, v46, v47
    v_mfma_f32_16x16x32_bf16 v[20:23], a[120:123], a[8:11], v[20:23]
    global_load_dwordx4 a[76:79], v3, s[44:45] offset:-1024 sc1
    v_mfma_f32_16x16x32_bf16 v[20:23], a[124:127], a[12:15], v[20:23]
    v_mfma_f32_16x16x32_bf16 v[24:27], a[96:99], a[16:19], v[68:71]
    v_exp_f32 v16, v16
    v_mfma_f32_16x16x32_bf16 v[24:27], a[100:103], a[20:23], v[24:27]
    v_exp_f32 v17, v17
    v_mfma_f32_16x16x32_bf16 v[24:27], a[104:107], a[24:27], v[24:27]
    v_cvt_pk_bf16_f32 v48, v16, v17
    v_mfma_f32_16x16x32_bf16 v[24:27], a[108:111], a[28:31], v[24:27]
    global_load_dwordx4 a[80:83], v3, s[44:45] offset:0 sc1
    v_mfma_f32_16x16x32_bf16 v[28:31], a[112:115], a[16:19], v[68:71]
    v_exp_f32 v18, v18
    v_mfma_f32_16x16x32_bf16 v[28:31], a[116:119], a[20:23], v[28:31]
    v_exp_f32 v19, v19
    v_mfma_f32_16x16x32_bf16 v[28:31], a[120:123], a[24:27], v[28:31]
    v_cvt_pk_bf16_f32 v49, v18, v19
    v_mfma_f32_16x16x32_bf16 v[28:31], a[124:127], a[28:31], v[28:31]
    global_load_dwordx4 a[84:87], v3, s[44:45] offset:1024 sc1
    v_mfma_f32_16x16x32_bf16 v[192:195], a[128:131], v[56:59], v[192:195]
    v_exp_f32 v20, v20
    v_mfma_f32_16x16x32_bf16 v[196:199], a[132:135], v[56:59], v[196:199]
    v_exp_f32 v21, v21
    v_mfma_f32_16x16x32_bf16 v[200:203], a[136:139], v[56:59], v[200:203]
    v_cvt_pk_bf16_f32 v50, v20, v21
    v_mfma_f32_16x16x32_bf16 v[204:207], a[140:143], v[56:59], v[204:207]
    global_load_dwordx4 a[88:91], v3, s[44:45] offset:2048 sc1
    v_mfma_f32_16x16x32_bf16 v[208:211], a[144:147], v[56:59], v[208:211]
    v_exp_f32 v22, v22
    v_mfma_f32_16x16x32_bf16 v[212:215], a[148:151], v[56:59], v[212:215]
    v_exp_f32 v23, v23
    v_mfma_f32_16x16x32_bf16 v[216:219], a[152:155], v[56:59], v[216:219]
    v_cvt_pk_bf16_f32 v51, v22, v23
    v_mfma_f32_16x16x32_bf16 v[220:223], a[156:159], v[56:59], v[220:223]
    global_load_dwordx4 a[92:95], v3, s[44:45] offset:3072 sc1
    v_mfma_f32_16x16x32_bf16 a[200:203], a[208:211], v[56:59], a[200:203]
    v_mfma_f32_16x16x32_bf16 v[224:227], a[128:131], v[60:63], v[224:227]
    v_exp_f32 v24, v24
    v_mfma_f32_16x16x32_bf16 v[228:231], a[132:135], v[60:63], v[228:231]
    v_exp_f32 v25, v25
    v_mfma_f32_16x16x32_bf16 v[232:235], a[136:139], v[60:63], v[232:235]
    v_cvt_pk_bf16_f32 v52, v24, v25
    v_mfma_f32_16x16x32_bf16 v[236:239], a[140:143], v[60:63], v[236:239]
    global_load_dwordx4 a[128:131], v3, s[46:47] offset:-4096 sc1
    v_mfma_f32_16x16x32_bf16 v[240:243], a[144:147], v[60:63], v[240:243]
    v_exp_f32 v26, v26
    v_mfma_f32_16x16x32_bf16 v[244:247], a[148:151], v[60:63], v[244:247]
    v_exp_f32 v27, v27
    v_mfma_f32_16x16x32_bf16 v[248:251], a[152:155], v[60:63], v[248:251]
    v_cvt_pk_bf16_f32 v53, v26, v27
    v_mfma_f32_16x16x32_bf16 v[252:255], a[156:159], v[60:63], v[252:255]
    global_load_dwordx4 a[132:135], v3, s[46:47] offset:-3072 sc1
    v_mfma_f32_16x16x32_bf16 a[204:207], a[208:211], v[60:63], a[204:207]
    v_exp_f32 v28, v28
    v_mfma_f32_16x16x32_bf16 v[32:35], a[96:99], a[32:35], v[72:75]
    v_exp_f32 v29, v29
    v_mfma_f32_16x16x32_bf16 v[32:35], a[100:103], a[36:39], v[32:35]
    v_cvt_pk_bf16_f32 v54, v28, v29
    v_mfma_f32_16x16x32_bf16 v[32:35], a[104:107], a[40:43], v[32:35]
    global_load_dwordx4 a[136:139], v3, s[46:47] offset:-2048 sc1
    v_mfma_f32_16x16x32_bf16 v[32:35], a[108:111], a[44:47], v[32:35]
    v_exp_f32 v30, v30
    v_mfma_f32_16x16x32_bf16 v[36:39], a[112:115], a[32:35], v[72:75]
    v_exp_f32 v31, v31
    v_mfma_f32_16x16x32_bf16 v[36:39], a[116:119], a[36:39], v[36:39]
    v_cvt_pk_bf16_f32 v55, v30, v31
    v_mfma_f32_16x16x32_bf16 v[36:39], a[120:123], a[40:43], v[36:39]
    global_load_dwordx4 a[140:143], v3, s[46:47] offset:-1024 sc1
    v_mfma_f32_16x16x32_bf16 v[36:39], a[124:127], a[44:47], v[36:39]
    v_mfma_f32_16x16x32_bf16 v[40:43], a[96:99], a[48:51], v[76:79]
    v_exp_f32 v32, v32
    v_mfma_f32_16x16x32_bf16 v[40:43], a[100:103], a[52:55], v[40:43]
    v_exp_f32 v33, v33
    v_mfma_f32_16x16x32_bf16 v[40:43], a[104:107], a[56:59], v[40:43]
    v_cvt_pk_bf16_f32 v56, v32, v33
    v_mfma_f32_16x16x32_bf16 v[40:43], a[108:111], a[60:63], v[40:43]
    global_load_dwordx4 a[144:147], v3, s[46:47] offset:0 sc1
    v_mfma_f32_16x16x32_bf16 v[44:47], a[112:115], a[48:51], v[76:79]
    v_exp_f32 v34, v34
    v_mfma_f32_16x16x32_bf16 v[44:47], a[116:119], a[52:55], v[44:47]
    v_exp_f32 v35, v35
    v_mfma_f32_16x16x32_bf16 v[44:47], a[120:123], a[56:59], v[44:47]
    v_cvt_pk_bf16_f32 v57, v34, v35
    v_mfma_f32_16x16x32_bf16 v[44:47], a[124:127], a[60:63], v[44:47]
    global_load_dwordx4 a[148:151], v3, s[46:47] offset:1024 sc1
    s_waitcnt vmcnt(14)
    v_mfma_f32_16x16x32_bf16 v[128:131], a[160:163], v[48:51], v[128:131]
    v_exp_f32 v36, v36
    v_mfma_f32_16x16x32_bf16 v[132:135], a[164:167], v[48:51], v[132:135]
    v_exp_f32 v37, v37
    v_mfma_f32_16x16x32_bf16 v[136:139], a[168:171], v[48:51], v[136:139]
    v_cvt_pk_bf16_f32 v58, v36, v37
    v_mfma_f32_16x16x32_bf16 v[140:143], a[172:175], v[48:51], v[140:143]
    global_load_dwordx4 a[152:155], v3, s[46:47] offset:2048 sc1
    v_mfma_f32_16x16x32_bf16 v[144:147], a[176:179], v[48:51], v[144:147]
    v_exp_f32 v38, v38
    v_mfma_f32_16x16x32_bf16 v[148:151], a[180:183], v[48:51], v[148:151]
    v_exp_f32 v39, v39
    v_mfma_f32_16x16x32_bf16 v[152:155], a[184:187], v[48:51], v[152:155]
    v_cvt_pk_bf16_f32 v59, v38, v39
    v_mfma_f32_16x16x32_bf16 v[156:159], a[188:191], v[48:51], v[156:159]
    global_load_dwordx4 a[156:159], v3, s[46:47] offset:3072 sc1
    v_mfma_f32_16x16x32_bf16 a[192:195], a[208:211], v[48:51], a[192:195]
    v_mfma_f32_16x16x32_bf16 v[160:163], a[160:163], v[52:55], v[160:163]
    v_exp_f32 v40, v40
    s_add_u32 s12, s12, 0x4000
    v_mfma_f32_16x16x32_bf16 v[164:167], a[164:167], v[52:55], v[164:167]
    v_exp_f32 v41, v41
    s_and_b32 s12, s12, 0x1ffff
    v_mfma_f32_16x16x32_bf16 v[168:171], a[168:171], v[52:55], v[168:171]
    v_cvt_pk_bf16_f32 v60, v40, v41
    v_add_u32 v3, s12, v1
    v_mfma_f32_16x16x32_bf16 v[172:175], a[172:175], v[52:55], v[172:175]
    global_load_dwordx4 a[96:99], v3, s[44:45] offset:-4096 sc1
    v_mfma_f32_16x16x32_bf16 v[176:179], a[176:179], v[52:55], v[176:179]
    v_exp_f32 v42, v42
    v_mfma_f32_16x16x32_bf16 v[180:183], a[180:183], v[52:55], v[180:183]
    v_exp_f32 v43, v43
    v_mfma_f32_16x16x32_bf16 v[184:187], a[184:187], v[52:55], v[184:187]
    v_cvt_pk_bf16_f32 v61, v42, v43
    v_mfma_f32_16x16x32_bf16 v[188:191], a[188:191], v[52:55], v[188:191]
    global_load_dwordx4 a[100:103], v3, s[44:45] offset:-3072 sc1
    v_mfma_f32_16x16x32_bf16 a[196:199], a[208:211], v[52:55], a[196:199]
    v_exp_f32 v44, v44
    s_waitcnt vmcnt(10)
    v_mfma_f32_16x16x32_bf16 v[16:19], a[64:67], a[0:3], v[64:67]
    v_exp_f32 v45, v45
    v_mfma_f32_16x16x32_bf16 v[16:19], a[68:71], a[4:7], v[16:19]
    v_cvt_pk_bf16_f32 v62, v44, v45
    v_mfma_f32_16x16x32_bf16 v[16:19], a[72:75], a[8:11], v[16:19]
    global_load_dwordx4 a[104:107], v3, s[44:45] offset:-2048 sc1
    v_mfma_f32_16x16x32_bf16 v[16:19], a[76:79], a[12:15], v[16:19]
    v_exp_f32 v46, v46
    v_mfma_f32_16x16x32_bf16 v[20:23], a[80:83], a[0:3], v[64:67]
    v_exp_f32 v47, v47
    v_mfma_f32_16x16x32_bf16 v[20:23], a[84:87], a[4:7], v[20:23]
    v_cvt_pk_bf16_f32 v63, v46, v47
    v_mfma_f32_16x16x32_bf16 v[20:23], a[88:91], a[8:11], v[20:23]
    global_load_dwordx4 a[108:111], v3, s[44:45] offset:-1024 sc1
    v_mfma_f32_16x16x32_bf16 v[20:23], a[92:95], a[12:15], v[20:23]
    v_mfma_f32_16x16x32_bf16 v[24:27], a[64:67], a[16:19], v[68:71]
    v_exp_f32 v16, v16
    v_mfma_f32_16x16x32_bf16 v[24:27], a[68:71], a[20:23], v[24:27]
    v_exp_f32 v17, v17
    v_mfma_f32_16x16x32_bf16 v[24:27], a[72:75], a[24:27], v[24:27]
    v_cvt_pk_bf16_f32 v48, v16, v17
    v_mfma_f32_16x16x32_bf16 v[24:27], a[76:79], a[28:31], v[24:27]
    global_load_dwordx4 a[112:115], v3, s[44:45] offset:0 sc1
    v_mfma_f32_16x16x32_bf16 v[28:31], a[80:83], a[16:19], v[68:71]
    v_exp_f32 v18, v18
    v_mfma_f32_16x16x32_bf16 v[28:31], a[84:87], a[20:23], v[28:31]
    v_exp_f32 v19, v19
    v_mfma_f32_16x16x32_bf16 v[28:31], a[88:91], a[24:27], v[28:31]
    v_cvt_pk_bf16_f32 v49, v18, v19
    v_mfma_f32_16x16x32_bf16 v[28:31], a[92:95], a[28:31], v[28:31]
    global_load_dwordx4 a[116:119], v3, s[44:45] offset:1024 sc1
    v_mfma_f32_16x16x32_bf16 v[192:195], a[160:163], v[56:59], v[192:195]
    v_exp_f32 v20, v20
    v_mfma_f32_16x16x32_bf16 v[196:199], a[164:167], v[56:59], v[196:199]
    v_exp_f32 v21, v21
    v_mfma_f32_16x16x32_bf16 v[200:203], a[168:171], v[56:59], v[200:203]
    v_cvt_pk_bf16_f32 v50, v20, v21
    v_mfma_f32_16x16x32_bf16 v[204:207], a[172:175], v[56:59], v[204:207]
    global_load_dwordx4 a[120:123], v3, s[44:45] offset:2048 sc1
    v_mfma_f32_16x16x32_bf16 v[208:211], a[176:179], v[56:59], v[208:211]
    v_exp_f32 v22, v22
    v_mfma_f32_16x16x32_bf16 v[212:215], a[180:183], v[56:59], v[212:215]
    v_exp_f32 v23, v23
    v_mfma_f32_16x16x32_bf16 v[216:219], a[184:187], v[56:59], v[216:219]
    v_cvt_pk_bf16_f32 v51, v22, v23
    v_mfma_f32_16x16x32_bf16 v[220:223], a[188:191], v[56:59], v[220:223]
    global_load_dwordx4 a[124:127], v3, s[44:45] offset:3072 sc1
    v_mfma_f32_16x16x32_bf16 a[200:203], a[208:211], v[56:59], a[200:203]
    v_mfma_f32_16x16x32_bf16 v[224:227], a[160:163], v[60:63], v[224:227]
    v_exp_f32 v24, v24
    v_mfma_f32_16x16x32_bf16 v[228:231], a[164:167], v[60:63], v[228:231]
    v_exp_f32 v25, v25
    v_mfma_f32_16x16x32_bf16 v[232:235], a[168:171], v[60:63], v[232:235]
    v_cvt_pk_bf16_f32 v52, v24, v25
    v_mfma_f32_16x16x32_bf16 v[236:239], a[172:175], v[60:63], v[236:239]
    global_load_dwordx4 a[160:163], v3, s[46:47] offset:-4096 sc1
    v_mfma_f32_16x16x32_bf16 v[240:243], a[176:179], v[60:63], v[240:243]
    v_exp_f32 v26, v26
    v_mfma_f32_16x16x32_bf16 v[244:247], a[180:183], v[60:63], v[244:247]
    v_exp_f32 v27, v27
    v_mfma_f32_16x16x32_bf16 v[248:251], a[184:187], v[60:63], v[248:251]
    v_cvt_pk_bf16_f32 v53, v26, v27
    v_mfma_f32_16x16x32_bf16 v[252:255], a[188:191], v[60:63], v[252:255]
    global_load_dwordx4 a[164:167], v3, s[46:47] offset:-3072 sc1
    v_mfma_f32_16x16x32_bf16 a[204:207], a[208:211], v[60:63], a[204:207]
    v_exp_f32 v28, v28
    v_mfma_f32_16x16x32_bf16 v[32:35], a[64:67], a[32:35], v[72:75]
    v_exp_f32 v29, v29
    v_mfma_f32_16x16x32_bf16 v[32:35], a[68:71], a[36:39], v[32:35]
    v_cvt_pk_bf16_f32 v54, v28, v29
    v_mfma_f32_16x16x32_bf16 v[32:35], a[72:75], a[40:43], v[32:35]
    global_load_dwordx4 a[168:171], v3, s[46:47] offset:-2048 sc1
    v_mfma_f32_16x16x32_bf16 v[32:35], a[76:79], a[44:47], v[32:35]
    v_exp_f32 v30, v30
    v_mfma_f32_16x16x32_bf16 v[36:39], a[80:83], a[32:35], v[72:75]
    v_exp_f32 v31, v31
    v_mfma_f32_16x16x32_bf16 v[36:39], a[84:87], a[36:39], v[36:39]
    v_cvt_pk_bf16_f32 v55, v30, v31
    v_mfma_f32_16x16x32_bf16 v[36:39], a[88:91], a[40:43], v[36:39]
    global_load_dwordx4 a[172:175], v3, s[46:47] offset:-1024 sc1
    v_mfma_f32_16x16x32_bf16 v[36:39], a[92:95], a[44:47], v[36:39]
    v_mfma_f32_16x16x32_bf16 v[40:43], a[64:67], a[48:51], v[76:79]
    v_exp_f32 v32, v32
    v_mfma_f32_16x16x32_bf16 v[40:43], a[68:71], a[52:55], v[40:43]
    v_exp_f32 v33, v33
    v_mfma_f32_16x16x32_bf16 v[40:43], a[72:75], a[56:59], v[40:43]
    v_cvt_pk_bf16_f32 v56, v32, v33
    v_mfma_f32_16x16x32_bf16 v[40:43], a[76:79], a[60:63], v[40:43]
    global_load_dwordx4 a[176:179], v3, s[46:47] offset:0 sc1
    v_mfma_f32_16x16x32_bf16 v[44:47], a[80:83], a[48:51], v[76:79]
    v_exp_f32 v34, v34
    v_mfma_f32_16x16x32_bf16 v[44:47], a[84:87], a[52:55], v[44:47]
    v_exp_f32 v35, v35
    v_mfma_f32_16x16x32_bf16 v[44:47], a[88:91], a[56:59], v[44:47]
    v_cvt_pk_bf16_f32 v57, v34, v35
    v_mfma_f32_16x16x32_bf16 v[44:47], a[92:95], a[60:63], v[44:47]
    global_load_dwordx4 a[180:183], v3, s[46:47] offset:1024 sc1
    s_waitcnt vmcnt(14)
    v_mfma_f32_16x16x32_bf16 v[128:131], a[128:131], v[48:51], v[128:131]
    v_exp_f32 v36, v36
    v_mfma_f32_16x16x32_bf16 v[132:135], a[132:135], v[48:51], v[132:135]
    v_exp_f32 v37, v37
    v_mfma_f32_16x16x32_bf16 v[136:139], a[136:139], v[48:51], v[136:139]
    v_cvt_pk_bf16_f32 v58, v36, v37
    v_mfma_f32_16x16x32_bf16 v[140:143], a[140:143], v[48:51], v[140:143]
    global_load_dwordx4 a[184:187], v3, s[46:47] offset:2048 sc1
    v_mfma_f32_16x16x32_bf16 v[144:147], a[144:147], v[48:51], v[144:147]
    v_exp_f32 v38, v38
    v_mfma_f32_16x16x32_bf16 v[148:151], a[148:151], v[48:51], v[148:151]
    v_exp_f32 v39, v39
    v_mfma_f32_16x16x32_bf16 v[152:155], a[152:155], v[48:51], v[152:155]
    v_cvt_pk_bf16_f32 v59, v38, v39
    v_mfma_f32_16x16x32_bf16 v[156:159], a[156:159], v[48:51], v[156:159]
    global_load_dwordx4 a[188:191], v3, s[46:47] offset:3072 sc1
    v_mfma_f32_16x16x32_bf16 a[192:195], a[208:211], v[48:51], a[192:195]
    v_mfma_f32_16x16x32_bf16 v[160:163], a[128:131], v[52:55], v[160:163]
    v_exp_f32 v40, v40
    s_add_u32 s12, s12, 0x4000
    v_mfma_f32_16x16x32_bf16 v[164:167], a[132:135], v[52:55], v[164:167]
    v_exp_f32 v41, v41
    s_and_b32 s12, s12, 0x1ffff
    v_mfma_f32_16x16x32_bf16 v[168:171], a[136:139], v[52:55], v[168:171]
    v_cvt_pk_bf16_f32 v60, v40, v41
    v_add_u32 v3, s12, v1
    v_mfma_f32_16x16x32_bf16 v[172:175], a[140:143], v[52:55], v[172:175]
    global_load_dwordx4 a[64:67], v3, s[44:45] offset:-4096 sc1
    v_mfma_f32_16x16x32_bf16 v[176:179], a[144:147], v[52:55], v[176:179]
    v_exp_f32 v42, v42
    v_mfma_f32_16x16x32_bf16 v[180:183], a[148:151], v[52:55], v[180:183]
    v_exp_f32 v43, v43
    v_mfma_f32_16x16x32_bf16 v[184:187], a[152:155], v[52:55], v[184:187]
    v_cvt_pk_bf16_f32 v61, v42, v43
    v_mfma_f32_16x16x32_bf16 v[188:191], a[156:159], v[52:55], v[188:191]
    global_load_dwordx4 a[68:71], v3, s[44:45] offset:-3072 sc1
    v_mfma_f32_16x16x32_bf16 a[196:199], a[208:211], v[52:55], a[196:199]
    v_exp_f32 v44, v44
    s_add_u32 s51, s51, 1
    s_cmp_lt_u32 s51, 3
    s_cbranch_scc1 L_loop
    s_lshl_b32 s99, s8, 13
    s_add_u32 s99, s99, 9216
    s_add_u32 s98, s8, 1
    s_and_b32 s98, s98, 3
    s_lshl_b32 s98, s98, 15
    s_add_u32 s98, s98, s99
    v_add_u32 v9, s98, v2
    s_add_u32 s98, s8, 2
    s_and_b32 s98, s98, 3
    s_lshl_b32 s98, s98, 15
    s_add_u32 s98, s98, s99
    v_add_u32 v10, s98, v2
    s_add_u32 s98, s8, 3
    s_and_b32 s98, s98, 3
    s_lshl_b32 s98, s98, 15
    s_add_u32 s98, s98, s99
    v_add_u32 v11, s98, v2
    s_waitcnt vmcnt(10)
    v_mfma_f32_16x16x32_bf16 v[16:19], a[96:99], a[0:3], v[64:67]
    v_exp_f32 v45, v45
    v_mfma_f32_16x16x32_bf16 v[16:19], a[100:103], a[4:7], v[16:19]
    v_cvt_pk_bf16_f32 v62, v44, v45
    v_mfma_f32_16x16x32_bf16 v[16:19], a[104:107], a[8:11], v[16:19]
    global_load_dwordx4 a[72:75], v3, s[44:45] offset:-2048 sc1
    v_mfma_f32_16x16x32_bf16 v[16:19], a[108:111], a[12:15], v[16:19]
    v_exp_f32 v46, v46
    v_mfma_f32_16x16x32_bf16 v[20:23], a[112:115], a[0:3], v[64:67]
    v_exp_f32 v47, v47
    v_mfma_f32_16x16x32_bf16 v[20:23], a[116:119], a[4:7], v[20:23]
    v_cvt_pk_bf16_f32 v63, v46, v47
    v_mfma_f32_16x16x32_bf16 v[20:23], a[120:123], a[8:11], v[20:23]
    global_load_dwordx4 a[76:79], v3, s[44:45] offset:-1024 sc1
    v_mfma_f32_16x16x32_bf16 v[20:23], a[124:127], a[12:15], v[20:23]
    v_mfma_f32_16x16x32_bf16 v[24:27], a[96:99], a[16:19], v[68:71]
    v_exp_f32 v16, v16
    v_mfma_f32_16x16x32_bf16 v[24:27], a[100:103], a[20:23], v[24:27]
    v_exp_f32 v17, v17
    v_mfma_f32_16x16x32_bf16 v[24:27], a[104:107], a[24:27], v[24:27]
    v_cvt_pk_bf16_f32 v48, v16, v17
    v_mfma_f32_16x16x32_bf16 v[24:27], a[108:111], a[28:31], v[24:27]
    global_load_dwordx4 a[80:83], v3, s[44:45] offset:0 sc1
    v_mfma_f32_16x16x32_bf16 v[28:31], a[112:115], a[16:19], v[68:71]
    v_exp_f32 v18, v18
    v_mfma_f32_16x16x32_bf16 v[28:31], a[116:119], a[20:23], v[28:31]
    v_exp_f32 v19, v19
    v_mfma_f32_16x16x32_bf16 v[28:31], a[120:123], a[24:27], v[28:31]
    v_cvt_pk_bf16_f32 v49, v18, v19
    v_mfma_f32_16x16x32_bf16 v[28:31], a[124:127], a[28:31], v[28:31]
    global_load_dwordx4 a[84:87], v3, s[44:45] offset:1024 sc1
    v_mfma_f32_16x16x32_bf16 v[192:195], a[128:131], v[56:59], v[192:195]
    v_exp_f32 v20, v20
    v_mfma_f32_16x16x32_bf16 v[196:199], a[132:135], v[56:59], v[196:199]
    v_exp_f32 v21, v21
    v_mfma_f32_16x16x32_bf16 v[200:203], a[136:139], v[56:59], v[200:203]
    v_cvt_pk_bf16_f32 v50, v20, v21
    v_mfma_f32_16x16x32_bf16 v[204:207], a[140:143], v[56:59], v[204:207]
    global_load_dwordx4 a[88:91], v3, s[44:45] offset:2048 sc1
    v_mfma_f32_16x16x32_bf16 v[208:211], a[144:147], v[56:59], v[208:211]
    v_exp_f32 v22, v22
    v_mfma_f32_16x16x32_bf16 v[212:215], a[148:151], v[56:59], v[212:215]
    v_exp_f32 v23, v23
    v_mfma_f32_16x16x32_bf16 v[216:219], a[152:155], v[56:59], v[216:219]
    v_cvt_pk_bf16_f32 v51, v22, v23
    v_mfma_f32_16x16x32_bf16 v[220:223], a[156:159], v[56:59], v[220:223]
    global_load_dwordx4 a[92:95], v3, s[44:45] offset:3072 sc1
    v_mfma_f32_16x16x32_bf16 a[200:203], a[208:211], v[56:59], a[200:203]
    v_mfma_f32_16x16x32_bf16 v[224:227], a[128:131], v[60:63], v[224:227]
    v_exp_f32 v24, v24
    v_mfma_f32_16x16x32_bf16 v[228:231], a[132:135], v[60:63], v[228:231]
    v_exp_f32 v25, v25
    v_mfma_f32_16x16x32_bf16 v[232:235], a[136:139], v[60:63], v[232:235]
    v_cvt_pk_bf16_f32 v52, v24, v25
    v_mfma_f32_16x16x32_bf16 v[236:239], a[140:143], v[60:63], v[236:239]
    global_load_dwordx4 a[128:131], v3, s[46:47] offset:-4096 sc1
    v_mfma_f32_16x16x32_bf16 v[240:243], a[144:147], v[60:63], v[240:243]
    v_exp_f32 v26, v26
    v_mfma_f32_16x16x32_bf16 v[244:247], a[148:151], v[60:63], v[244:247]
    v_exp_f32 v27, v27
    v_mfma_f32_16x16x32_bf16 v[248:251], a[152:155], v[60:63], v[248:251]
    v_cvt_pk_bf16_f32 v53, v26, v27
    v_mfma_f32_16x16x32_bf16 v[252:255], a[156:159], v[60:63], v[252:255]
    global_load_dwordx4 a[132:135], v3, s[46:47] offset:-3072 sc1
    v_mfma_f32_16x16x32_bf16 a[204:207], a[208:211], v[60:63], a[204:207]
    v_exp_f32 v28, v28
    v_mfma_f32_16x16x32_bf16 v[32:35], a[96:99], a[32:35], v[72:75]
    v_exp_f32 v29, v29
    v_mfma_f32_16x16x32_bf16 v[32:35], a[100:103], a[36:39], v[32:35]
    v_cvt_pk_bf16_f32 v54, v28, v29
    v_mfma_f32_16x16x32_bf16 v[32:35], a[104:107], a[40:43], v[32:35]
    global_load_dwordx4 a[136:139], v3, s[46:47] offset:-2048 sc1
    v_mfma_f32_16x16x32_bf16 v[32:35], a[108:111], a[44:47], v[32:35]
    v_exp_f32 v30, v30
    v_mfma_f32_16x16x32_bf16 v[36:39], a[112:115], a[32:35], v[72:75]
    v_exp_f32 v31, v31
    v_mfma_f32_16x16x32_bf16 v[36:39], a[116:119], a[36:39], v[36:39]
    v_cvt_pk_bf16_f32 v55, v30, v31
    v_mfma_f32_16x16x32_bf16 v[36:39], a[120:123], a[40:43], v[36:39]
    global_load_dwordx4 a[140:143], v3, s[46:47] offset:-1024 sc1
    v_mfma_f32_16x16x32_bf16 v[36:39], a[124:127], a[44:47], v[36:39]
    v_mfma_f32_16x16x32_bf16 v[40:43], a[96:99], a[48:51], v[76:79]
    v_exp_f32 v32, v32
    v_mfma_f32_16x16x32_bf16 v[40:43], a[100:103], a[52:55], v[40:43]
    v_exp_f32 v33, v33
    v_mfma_f32_16x16x32_bf16 v[40:43], a[104:107], a[56:59], v[40:43]
    v_cvt_pk_bf16_f32 v56, v32, v33
    v_mfma_f32_16x16x32_bf16 v[40:43], a[108:111], a[60:63], v[40:43]
    global_load_dwordx4 a[144:147], v3, s[46:47] offset:0 sc1
    v_mfma_f32_16x16x32_bf16 v[44:47], a[112:115], a[48:51], v[76:79]
    v_exp_f32 v34, v34
    v_mfma_f32_16x16x32_bf16 v[44:47], a[116:119], a[52:55], v[44:47]
    v_exp_f32 v35, v35
    v_mfma_f32_16x16x32_bf16 v[44:47], a[120:123], a[56:59], v[44:47]
    v_cvt_pk_bf16_f32 v57, v34, v35
    v_mfma_f32_16x16x32_bf16 v[44:47], a[124:127], a[60:63], v[44:47]
    global_load_dwordx4 a[148:151], v3, s[46:47] offset:1024 sc1
    s_waitcnt vmcnt(14)
    v_mfma_f32_16x16x32_bf16 v[128:131], a[160:163], v[48:51], v[128:131]
    v_exp_f32 v36, v36
    v_mfma_f32_16x16x32_bf16 v[132:135], a[164:167], v[48:51], v[132:135]
    v_exp_f32 v37, v37
    v_mfma_f32_16x16x32_bf16 v[136:139], a[168:171], v[48:51], v[136:139]
    v_cvt_pk_bf16_f32 v58, v36, v37
    v_mfma_f32_16x16x32_bf16 v[140:143], a[172:175], v[48:51], v[140:143]
    global_load_dwordx4 a[152:155], v3, s[46:47] offset:2048 sc1
    v_mfma_f32_16x16x32_bf16 v[144:147], a[176:179], v[48:51], v[144:147]
    v_exp_f32 v38, v38
    v_mfma_f32_16x16x32_bf16 v[148:151], a[180:183], v[48:51], v[148:151]
    v_exp_f32 v39, v39
    v_mfma_f32_16x16x32_bf16 v[152:155], a[184:187], v[48:51], v[152:155]
    v_cvt_pk_bf16_f32 v59, v38, v39
    v_mfma_f32_16x16x32_bf16 v[156:159], a[188:191], v[48:51], v[156:159]
    global_load_dwordx4 a[156:159], v3, s[46:47] offset:3072 sc1
    v_mfma_f32_16x16x32_bf16 a[192:195], a[208:211], v[48:51], a[192:195]
    v_mfma_f32_16x16x32_bf16 v[160:163], a[160:163], v[52:55], v[160:163]
    v_exp_f32 v40, v40
    v_mfma_f32_16x16x32_bf16 v[164:167], a[164:167], v[52:55], v[164:167]
    v_exp_f32 v41, v41
    v_mfma_f32_16x16x32_bf16 v[168:171], a[168:171], v[52:55], v[168:171]
    v_cvt_pk_bf16_f32 v60, v40, v41
    s_add_u32 s12, s11, 15
    s_and_b32 s12, s12, 7
    s_lshl_b32 s12, s12, 14
    v_add_u32 v3, s12, v1
    v_mfma_f32_16x16x32_bf16 v[172:175], a[172:175], v[52:55], v[172:175]
    global_load_dwordx4 a[96:99], v3, s[44:45] offset:-4096 sc1
    v_mfma_f32_16x16x32_bf16 v[176:179], a[176:179], v[52:55], v[176:179]
    v_exp_f32 v42, v42
    v_mfma_f32_16x16x32_bf16 v[180:183], a[180:183], v[52:55], v[180:183]
    v_exp_f32 v43, v43
    v_mfma_f32_16x16x32_bf16 v[184:187], a[184:187], v[52:55], v[184:187]
    v_cvt_pk_bf16_f32 v61, v42, v43
    v_mfma_f32_16x16x32_bf16 v[188:191], a[188:191], v[52:55], v[188:191]
    global_load_dwordx4 a[100:103], v3, s[44:45] offset:-3072 sc1
    v_mfma_f32_16x16x32_bf16 a[196:199], a[208:211], v[52:55], a[196:199]
    v_exp_f32 v44, v44
    s_waitcnt vmcnt(10)
    v_mfma_f32_16x16x32_bf16 v[16:19], a[64:67], a[0:3], v[64:67]
    v_exp_f32 v45, v45
    v_mfma_f32_16x16x32_bf16 v[16:19], a[68:71], a[4:7], v[16:19]
    v_cvt_pk_bf16_f32 v62, v44, v45
    v_mfma_f32_16x16x32_bf16 v[16:19], a[72:75], a[8:11], v[16:19]
    global_load_dwordx4 a[104:107], v3, s[44:45] offset:-2048 sc1
    v_mfma_f32_16x16x32_bf16 v[16:19], a[76:79], a[12:15], v[16:19]
    v_exp_f32 v46, v46
    v_mfma_f32_16x16x32_bf16 v[20:23], a[80:83], a[0:3], v[64:67]
    v_exp_f32 v47, v47
    v_mfma_f32_16x16x32_bf16 v[20:23], a[84:87], a[4:7], v[20:23]
    v_cvt_pk_bf16_f32 v63, v46, v47
    v_mfma_f32_16x16x32_bf16 v[20:23], a[88:91], a[8:11], v[20:23]
    global_load_dwordx4 a[108:111], v3, s[44:45] offset:-1024 sc1
    v_mfma_f32_16x16x32_bf16 v[20:23], a[92:95], a[12:15], v[20:23]
    v_mfma_f32_16x16x32_bf16 v[24:27], a[64:67], a[16:19], v[68:71]
    v_exp_f32 v16, v16
    v_mfma_f32_16x16x32_bf16 v[24:27], a[68:71], a[20:23], v[24:27]
    v_exp_f32 v17, v17
    v_mfma_f32_16x16x32_bf16 v[24:27], a[72:75], a[24:27], v[24:27]
    v_cvt_pk_bf16_f32 v48, v16, v17
    v_mfma_f32_16x16x32_bf16 v[24:27], a[76:79], a[28:31], v[24:27]
    global_load_dwordx4 a[112:115], v3, s[44:45] offset:0 sc1
    v_mfma_f32_16x16x32_bf16 v[28:31], a[80:83], a[16:19], v[68:71]
    v_exp_f32 v18, v18
    v_mfma_f32_16x16x32_bf16 v[28:31], a[84:87], a[20:23], v[28:31]
    v_exp_f32 v19, v19
    v_mfma_f32_16x16x32_bf16 v[28:31], a[88:91], a[24:27], v[28:31]
    v_cvt_pk_bf16_f32 v49, v18, v19
    v_mfma_f32_16x16x32_bf16 v[28:31], a[92:95], a[28:31], v[28:31]
    global_load_dwordx4 a[116:119], v3, s[44:45] offset:1024 sc1
    v_mfma_f32_16x16x32_bf16 v[192:195], a[160:163], v[56:59], v[192:195]
    v_exp_f32 v20, v20
    v_mfma_f32_16x16x32_bf16 v[196:199], a[164:167], v[56:59], v[196:199]
    v_exp_f32 v21, v21
    v_mfma_f32_16x16x32_bf16 v[200:203], a[168:171], v[56:59], v[200:203]
    v_cvt_pk_bf16_f32 v50, v20, v21
    v_mfma_f32_16x16x32_bf16 v[204:207], a[172:175], v[56:59], v[204:207]
    global_load_dwordx4 a[120:123], v3, s[44:45] offset:2048 sc1
    v_mfma_f32_16x16x32_bf16 v[208:211], a[176:179], v[56:59], v[208:211]
    v_exp_f32 v22, v22
    v_mfma_f32_16x16x32_bf16 v[212:215], a[180:183], v[56:59], v[212:215]
    v_exp_f32 v23, v23
    v_mfma_f32_16x16x32_bf16 v[216:219], a[184:187], v[56:59], v[216:219]
    v_cvt_pk_bf16_f32 v51, v22, v23
    v_mfma_f32_16x16x32_bf16 v[220:223], a[188:191], v[56:59], v[220:223]
    global_load_dwordx4 a[124:127], v3, s[44:45] offset:3072 sc1
    v_mfma_f32_16x16x32_bf16 a[200:203], a[208:211], v[56:59], a[200:203]
    v_mfma_f32_16x16x32_bf16 v[224:227], a[160:163], v[60:63], v[224:227]
    v_exp_f32 v24, v24
    v_mfma_f32_16x16x32_bf16 v[228:231], a[164:167], v[60:63], v[228:231]
    v_exp_f32 v25, v25
    v_mfma_f32_16x16x32_bf16 v[232:235], a[168:171], v[60:63], v[232:235]
    v_cvt_pk_bf16_f32 v52, v24, v25
    v_mfma_f32_16x16x32_bf16 v[236:239], a[172:175], v[60:63], v[236:239]
    global_load_dwordx4 a[160:163], v3, s[46:47] offset:-4096 sc1
    v_mfma_f32_16x16x32_bf16 v[240:243], a[176:179], v[60:63], v[240:243]
    v_exp_f32 v26, v26
    v_mfma_f32_16x16x32_bf16 v[244:247], a[180:183], v[60:63], v[244:247]
    v_exp_f32 v27, v27
    v_mfma_f32_16x16x32_bf16 v[248:251], a[184:187], v[60:63], v[248:251]
    v_cvt_pk_bf16_f32 v53, v26, v27
    v_mfma_f32_16x16x32_bf16 v[252:255], a[188:191], v[60:63], v[252:255]
    global_load_dwordx4 a[164:167], v3, s[46:47] offset:-3072 sc1
    v_mfma_f32_16x16x32_bf16 a[204:207], a[208:211], v[60:63], a[204:207]
    v_exp_f32 v28, v28
    v_mfma_f32_16x16x32_bf16 v[32:35], a[64:67], a[32:35], v[72:75]
    v_exp_f32 v29, v29
    v_mfma_f32_16x16x32_bf16 v[32:35], a[68:71], a[36:39], v[32:35]
    v_cvt_pk_bf16_f32 v54, v28, v29
    v_mfma_f32_16x16x32_bf16 v[32:35], a[72:75], a[40:43], v[32:35]
    global_load_dwordx4 a[168:171], v3, s[46:47] offset:-2048 sc1
    v_mfma_f32_16x16x32_bf16 v[32:35], a[76:79], a[44:47], v[32:35]
    v_exp_f32 v30, v30
    v_mfma_f32_16x16x32_bf16 v[36:39], a[80:83], a[32:35], v[72:75]
    v_exp_f32 v31, v31
    v_mfma_f32_16x16x32_bf16 v[36:39], a[84:87], a[36:39], v[36:39]
    v_cvt_pk_bf16_f32 v55, v30, v31
    v_mfma_f32_16x16x32_bf16 v[36:39], a[88:91], a[40:43], v[36:39]
    global_load_dwordx4 a[172:175], v3, s[46:47] offset:-1024 sc1
    v_mfma_f32_16x16x32_bf16 v[36:39], a[92:95], a[44:47], v[36:39]
    v_mfma_f32_16x16x32_bf16 v[40:43], a[64:67], a[48:51], v[76:79]
    v_exp_f32 v32, v32
    v_mfma_f32_16x16x32_bf16 v[40:43], a[68:71], a[52:55], v[40:43]
    v_exp_f32 v33, v33
    v_mfma_f32_16x16x32_bf16 v[40:43], a[72:75], a[56:59], v[40:43]
    v_cvt_pk_bf16_f32 v56, v32, v33
    v_mfma_f32_16x16x32_bf16 v[40:43], a[76:79], a[60:63], v[40:43]
    global_load_dwordx4 a[176:179], v3, s[46:47] offset:0 sc1
    v_mfma_f32_16x16x32_bf16 v[44:47], a[80:83], a[48:51], v[76:79]
    v_exp_f32 v34, v34
    v_mfma_f32_16x16x32_bf16 v[44:47], a[84:87], a[52:55], v[44:47]
    v_exp_f32 v35, v35
    v_mfma_f32_16x16x32_bf16 v[44:47], a[88:91], a[56:59], v[44:47]
    v_cvt_pk_bf16_f32 v57, v34, v35
    v_mfma_f32_16x16x32_bf16 v[44:47], a[92:95], a[60:63], v[44:47]
    global_load_dwordx4 a[180:183], v3, s[46:47] offset:1024 sc1
    s_waitcnt vmcnt(14)
    v_mfma_f32_16x16x32_bf16 v[128:131], a[128:131], v[48:51], v[128:131]
    v_exp_f32 v36, v36
    v_mfma_f32_16x16x32_bf16 v[132:135], a[132:135], v[48:51], v[132:135]
    v_exp_f32 v37, v37
    v_mfma_f32_16x16x32_bf16 v[136:139], a[136:139], v[48:51], v[136:139]
    v_cvt_pk_bf16_f32 v58, v36, v37
    v_mfma_f32_16x16x32_bf16 v[140:143], a[140:143], v[48:51], v[140:143]
    global_load_dwordx4 a[184:187], v3, s[46:47] offset:2048 sc1
    v_mfma_f32_16x16x32_bf16 v[144:147], a[144:147], v[48:51], v[144:147]
    v_exp_f32 v38, v38
    v_mfma_f32_16x16x32_bf16 v[148:151], a[148:151], v[48:51], v[148:151]
    v_exp_f32 v39, v39
    v_mfma_f32_16x16x32_bf16 v[152:155], a[152:155], v[48:51], v[152:155]
    v_cvt_pk_bf16_f32 v59, v38, v39
    v_mfma_f32_16x16x32_bf16 v[156:159], a[156:159], v[48:51], v[156:159]
    global_load_dwordx4 a[188:191], v3, s[46:47] offset:3072 sc1
    v_mfma_f32_16x16x32_bf16 a[192:195], a[208:211], v[48:51], a[192:195]
    v_mfma_f32_16x16x32_bf16 v[160:163], a[128:131], v[52:55], v[160:163]
    v_exp_f32 v40, v40
    v_mfma_f32_16x16x32_bf16 v[164:167], a[132:135], v[52:55], v[164:167]
    v_exp_f32 v41, v41
    v_mfma_f32_16x16x32_bf16 v[168:171], a[136:139], v[52:55], v[168:171]
    v_cvt_pk_bf16_f32 v60, v40, v41
    v_mfma_f32_16x16x32_bf16 v[172:175], a[140:143], v[52:55], v[172:175]
    v_mfma_f32_16x16x32_bf16 v[176:179], a[144:147], v[52:55], v[176:179]
    v_exp_f32 v42, v42
    v_mfma_f32_16x16x32_bf16 v[180:183], a[148:151], v[52:55], v[180:183]
    v_exp_f32 v43, v43
    v_mfma_f32_16x16x32_bf16 v[184:187], a[152:155], v[52:55], v[184:187]
    v_cvt_pk_bf16_f32 v61, v42, v43
    v_mfma_f32_16x16x32_bf16 v[188:191], a[156:159], v[52:55], v[188:191]
    v_mfma_f32_16x16x32_bf16 a[196:199], a[208:211], v[52:55], a[196:199]
    v_exp_f32 v44, v44
    s_waitcnt vmcnt(8)
    v_mfma_f32_16x16x32_bf16 v[16:19], a[96:99], a[0:3], v[64:67]
    v_exp_f32 v45, v45
    v_mfma_f32_16x16x32_bf16 v[16:19], a[100:103], a[4:7], v[16:19]
    v_cvt_pk_bf16_f32 v62, v44, v45
    v_mfma_f32_16x16x32_bf16 v[16:19], a[104:107], a[8:11], v[16:19]
    v_mfma_f32_16x16x32_bf16 v[16:19], a[108:111], a[12:15], v[16:19]
    v_exp_f32 v46, v46
    v_mfma_f32_16x16x32_bf16 v[20:23], a[112:115], a[0:3], v[64:67]
    v_exp_f32 v47, v47
    v_mfma_f32_16x16x32_bf16 v[20:23], a[116:119], a[4:7], v[20:23]
    v_cvt_pk_bf16_f32 v63, v46, v47
    v_mfma_f32_16x16x32_bf16 v[20:23], a[120:123], a[8:11], v[20:23]
    v_mfma_f32_16x16x32_bf16 v[20:23], a[124:127], a[12:15], v[20:23]
    v_mfma_f32_16x16x32_bf16 v[24:27], a[96:99], a[16:19], v[68:71]
    v_exp_f32 v16, v16
    v_mfma_f32_16x16x32_bf16 v[24:27], a[100:103], a[20:23], v[24:27]
    v_exp_f32 v17, v17
    v_mfma_f32_16x16x32_bf16 v[24:27], a[104:107], a[24:27], v[24:27]
    v_cvt_pk_bf16_f32 v48, v16, v17
    v_mfma_f32_16x16x32_bf16 v[24:27], a[108:111], a[28:31], v[24:27]
    v_mfma_f32_16x16x32_bf16 v[28:31], a[112:115], a[16:19], v[68:71]
    v_exp_f32 v18, v18
    v_mfma_f32_16x16x32_bf16 v[28:31], a[116:119], a[20:23], v[28:31]
    v_exp_f32 v19, v19
    v_mfma_f32_16x16x32_bf16 v[28:31], a[120:123], a[24:27], v[28:31]
    v_cvt_pk_bf16_f32 v49, v18, v19
    v_mfma_f32_16x16x32_bf16 v[28:31], a[124:127], a[28:31], v[28:31]
    v_mfma_f32_16x16x32_bf16 v[192:195], a[128:131], v[56:59], v[192:195]
    v_exp_f32 v20, v20
    v_mfma_f32_16x16x32_bf16 v[196:199], a[132:135], v[56:59], v[196:199]
    v_exp_f32 v21, v21
    v_mfma_f32_16x16x32_bf16 v[200:203], a[136:139], v[56:59], v[200:203]
    v_cvt_pk_bf16_f32 v50, v20, v21
    v_mfma_f32_16x16x32_bf16 v[204:207], a[140:143], v[56:59], v[204:207]
    v_mfma_f32_16x16x32_bf16 v[208:211], a[144:147], v[56:59], v[208:211]
    v_exp_f32 v22, v22
    v_mfma_f32_16x16x32_bf16 v[212:215], a[148:151], v[56:59], v[212:215]
    v_exp_f32 v23, v23
    v_mfma_f32_16x16x32_bf16 v[216:219], a[152:155], v[56:59], v[216:219]
    v_cvt_pk_bf16_f32 v51, v22, v23
    v_mfma_f32_16x16x32_bf16 v[220:223], a[156:159], v[56:59], v[220:223]
    v_mfma_f32_16x16x32_bf16 a[200:203], a[208:211], v[56:59], a[200:203]
    v_mfma_f32_16x16x32_bf16 v[224:227], a[128:131], v[60:63], v[224:227]
    v_exp_f32 v24, v24
    v_mfma_f32_16x16x32_bf16 v[228:231], a[132:135], v[60:63], v[228:231]
    v_exp_f32 v25, v25
    v_mfma_f32_16x16x32_bf16 v[232:235], a[136:139], v[60:63], v[232:235]
    v_cvt_pk_bf16_f32 v52, v24, v25
    v_mfma_f32_16x16x32_bf16 v[236:239], a[140:143], v[60:63], v[236:239]
    v_mfma_f32_16x16x32_bf16 v[240:243], a[144:147], v[60:63], v[240:243]
    v_exp_f32 v26, v26
    v_mfma_f32_16x16x32_bf16 v[244:247], a[148:151], v[60:63], v[244:247]
    v_exp_f32 v27, v27
    v_mfma_f32_16x16x32_bf16 v[248:251], a[152:155], v[60:63], v[248:251]
    v_cvt_pk_bf16_f32 v53, v26, v27
    v_mfma_f32_16x16x32_bf16 v[252:255], a[156:159], v[60:63], v[252:255]
    v_mfma_f32_16x16x32_bf16 a[204:207], a[208:211], v[60:63], a[204:207]
    v_exp_f32 v28, v28
    v_mfma_f32_16x16x32_bf16 v[32:35], a[96:99], a[32:35], v[72:75]
    v_exp_f32 v29, v29
    v_mfma_f32_16x16x32_bf16 v[32:35], a[100:103], a[36:39], v[32:35]
    v_cvt_pk_bf16_f32 v54, v28, v29
    v_mfma_f32_16x16x32_bf16 v[32:35], a[104:107], a[40:43], v[32:35]
    v_mfma_f32_16x16x32_bf16 v[32:35], a[108:111], a[44:47], v[32:35]
    v_exp_f32 v30, v30
    v_mfma_f32_16x16x32_bf16 v[36:39], a[112:115], a[32:35], v[72:75]
    v_exp_f32 v31, v31
    v_mfma_f32_16x16x32_bf16 v[36:39], a[116:119], a[36:39], v[36:39]
    v_cvt_pk_bf16_f32 v55, v30, v31
    v_mfma_f32_16x16x32_bf16 v[36:39], a[120:123], a[40:43], v[36:39]
    v_mfma_f32_16x16x32_bf16 v[36:39], a[124:127], a[44:47], v[36:39]
    v_mfma_f32_16x16x32_bf16 v[40:43], a[96:99], a[48:51], v[76:79]
    v_exp_f32 v32, v32
    v_mfma_f32_16x16x32_bf16 v[40:43], a[100:103], a[52:55], v[40:43]
    v_exp_f32 v33, v33
    v_mfma_f32_16x16x32_bf16 v[40:43], a[104:107], a[56:59], v[40:43]
    v_cvt_pk_bf16_f32 v56, v32, v33
    v_mfma_f32_16x16x32_bf16 v[40:43], a[108:111], a[60:63], v[40:43]
    v_mfma_f32_16x16x32_bf16 v[44:47], a[112:115], a[48:51], v[76:79]
    v_exp_f32 v34, v34
    v_mfma_f32_16x16x32_bf16 v[44:47], a[116:119], a[52:55], v[44:47]
    v_exp_f32 v35, v35
    v_mfma_f32_16x16x32_bf16 v[44:47], a[120:123], a[56:59], v[44:47]
    v_cvt_pk_bf16_f32 v57, v34, v35
    v_mfma_f32_16x16x32_bf16 v[44:47], a[124:127], a[60:63], v[44:47]
    s_waitcnt vmcnt(0)
    v_mfma_f32_16x16x32_bf16 v[128:131], a[160:163], v[48:51], v[128:131]
    v_exp_f32 v36, v36
    v_mfma_f32_16x16x32_bf16 v[132:135], a[164:167], v[48:51], v[132:135]
    v_exp_f32 v37, v37
    v_mfma_f32_16x16x32_bf16 v[136:139], a[168:171], v[48:51], v[136:139]
    v_cvt_pk_bf16_f32 v58, v36, v37
    v_mfma_f32_16x16x32_bf16 v[140:143], a[172:175], v[48:51], v[140:143]
    v_mfma_f32_16x16x32_bf16 v[144:147], a[176:179], v[48:51], v[144:147]
    v_exp_f32 v38, v38
    v_mfma_f32_16x16x32_bf16 v[148:151], a[180:183], v[48:51], v[148:151]
    v_exp_f32 v39, v39
    v_mfma_f32_16x16x32_bf16 v[152:155], a[184:187], v[48:51], v[152:155]
    v_cvt_pk_bf16_f32 v59, v38, v39
    v_mfma_f32_16x16x32_bf16 v[156:159], a[188:191], v[48:51], v[156:159]
    v_mfma_f32_16x16x32_bf16 a[192:195], a[208:211], v[48:51], a[192:195]
    v_mfma_f32_16x16x32_bf16 v[160:163], a[160:163], v[52:55], v[160:163]
    v_exp_f32 v40, v40
    v_mfma_f32_16x16x32_bf16 v[164:167], a[164:167], v[52:55], v[164:167]
    v_exp_f32 v41, v41
    v_mfma_f32_16x16x32_bf16 v[168:171], a[168:171], v[52:55], v[168:171]
    v_cvt_pk_bf16_f32 v60, v40, v41
    v_mfma_f32_16x16x32_bf16 v[172:175], a[172:175], v[52:55], v[172:175]
    v_mfma_f32_16x16x32_bf16 v[176:179], a[176:179], v[52:55], v[176:179]
    v_exp_f32 v42, v42
    v_mfma_f32_16x16x32_bf16 v[180:183], a[180:183], v[52:55], v[180:183]
    v_exp_f32 v43, v43
    v_mfma_f32_16x16x32_bf16 v[184:187], a[184:187], v[52:55], v[184:187]
    v_cvt_pk_bf16_f32 v61, v42, v43
    v_mfma_f32_16x16x32_bf16 v[188:191], a[188:191], v[52:55], v[188:191]
    v_mfma_f32_16x16x32_bf16 a[196:199], a[208:211], v[52:55], a[196:199]
    v_exp_f32 v44, v44
    s_nop 1
    v_exp_f32 v45, v45
    s_nop 1
    v_cvt_pk_bf16_f32 v62, v44, v45
    s_nop 1
    ds_write_b128 v9, v[128:131] offset:0
    s_nop 1
    v_exp_f32 v46, v46
    s_nop 1
    v_exp_f32 v47, v47
    ds_write_b128 v9, v[132:135] offset:1024
    s_nop 1
    v_cvt_pk_bf16_f32 v63, v46, v47
    s_nop 1
    ds_write_b128 v9, v[136:139] offset:2048
    s_nop 1
    s_nop 1
    ds_write_b128 v9, v[140:143] offset:3072
    s_nop 1
    s_nop 1
    ds_write_b128 v9, v[144:147] offset:4096
    s_nop 1
    s_nop 1
    ds_write_b128 v9, v[148:151] offset:5120
    s_nop 1
    s_nop 1
    ds_write_b128 v9, v[152:155] offset:6144
    s_nop 1
    v_mfma_f32_16x16x32_bf16 v[192:195], a[160:163], v[56:59], v[192:195]
    ds_write_b128 v9, v[156:159] offset:7168
    v_mfma_f32_16x16x32_bf16 v[196:199], a[164:167], v[56:59], v[196:199]
    v_mfma_f32_16x16x32_bf16 v[200:203], a[168:171], v[56:59], v[200:203]
    ds_write_b128 v10, v[160:163] offset:0
    v_mfma_f32_16x16x32_bf16 v[204:207], a[172:175], v[56:59], v[204:207]
    v_mfma_f32_16x16x32_bf16 v[208:211], a[176:179], v[56:59], v[208:211]
    ds_write_b128 v10, v[164:167] offset:1024
    v_mfma_f32_16x16x32_bf16 v[212:215], a[180:183], v[56:59], v[212:215]
    v_mfma_f32_16x16x32_bf16 v[216:219], a[184:187], v[56:59], v[216:219]
    ds_write_b128 v10, v[168:171] offset:2048
    v_mfma_f32_16x16x32_bf16 v[220:223], a[188:191], v[56:59], v[220:223]
    v_mfma_f32_16x16x32_bf16 a[200:203], a[208:211], v[56:59], a[200:203]
    ds_write_b128 v10, v[172:175] offset:3072
    v_mfma_f32_16x16x32_bf16 v[224:227], a[160:163], v[60:63], v[224:227]
    v_mfma_f32_16x16x32_bf16 v[228:231], a[164:167], v[60:63], v[228:231]
    ds_write_b128 v10, v[176:179] offset:4096
    v_mfma_f32_16x16x32_bf16 v[232:235], a[168:171], v[60:63], v[232:235]
    v_mfma_f32_16x16x32_bf16 v[236:239], a[172:175], v[60:63], v[236:239]
    ds_write_b128 v10, v[180:183] offset:5120
    v_mfma_f32_16x16x32_bf16 v[240:243], a[176:179], v[60:63], v[240:243]
    v_mfma_f32_16x16x32_bf16 v[244:247], a[180:183], v[60:63], v[244:247]
    ds_write_b128 v10, v[184:187] offset:6144
    v_mfma_f32_16x16x32_bf16 v[248:251], a[184:187], v[60:63], v[248:251]
    v_mfma_f32_16x16x32_bf16 v[252:255], a[188:191], v[60:63], v[252:255]
    ds_write_b128 v10, v[188:191] offset:7168
    v_mfma_f32_16x16x32_bf16 a[204:207], a[208:211], v[60:63], a[204:207]
L_epi:
    v_lshrrev_b32 v5, 4, v0
    v_and_b32 v6, 15, v0
    s_lshl_b32 s99, s8, 2
    v_lshlrev_b32 v8, 4, v6
    v_add_u32 v8, s99, v8
    s_add_u32 s98, s8, 1
    s_and_b32 s98, s98, 3
    s_lshl_b32 s98, s98, 8
    v_add_u32 v16, s98, v8
    s_add_u32 s98, s8, 2
    s_and_b32 s98, s98, 3
    s_lshl_b32 s98, s98, 8
    v_add_u32 v17, s98, v8
    s_add_u32 s98, s8, 3
    s_and_b32 s98, s98, 3
    s_lshl_b32 s98, s98, 8
    v_add_u32 v18, s98, v8
    s_add_u32 s98, s8, 4
    s_and_b32 s98, s98, 3
    s_lshl_b32 s98, s98, 8
    v_add_u32_e64 v19, s98, v8
    ds_write_b128 v11, v[192:195] offset:0
    ds_write_b128 v11, v[196:199] offset:1024
    ds_write_b128 v11, v[200:203] offset:2048
    ds_write_b128 v11, v[204:207] offset:3072
    ds_write_b128 v11, v[208:211] offset:4096
    ds_write_b128 v11, v[212:215] offset:5120
    ds_write_b128 v11, v[216:219] offset:6144
    ds_write_b128 v11, v[220:223] offset:7168
    ds_write_b32 v16, a192
    ds_write_b32 v17, a196
    ds_write_b32 v18, a200
    ds_write_b32 v19, a204
    s_waitcnt lgkmcnt(0)
    s_barrier
    v_lshlrev_b32_e64 v8, 4, v6
    ds_read_b128 v[48:51], v8 offset:0
    ds_read_b128 v[52:55], v8 offset:256
    ds_read_b128 v[56:59], v8 offset:512
    ds_read_b128 v[60:63], v8 offset:768
    s_add_u32 s98, s8, 1
    s_and_b32 s98, s98, 3
    s_lshl_b32 s99, s8, 2
    s_add_u32 s98, s98, s99
    s_lshl_b32 s98, s98, 13
    s_nop 0
    s_add_u32 s98, s98, 9216
    v_add_u32_e64 v10, s98, v2
    ds_read_b128 v[128:131], v10 offset:0
    ds_read_b128 v[132:135], v10 offset:1024
    ds_read_b128 v[136:139], v10 offset:2048
    ds_read_b128 v[140:143], v10 offset:3072
    ds_read_b128 v[144:147], v10 offset:4096
    ds_read_b128 v[148:151], v10 offset:5120
    ds_read_b128 v[152:155], v10 offset:6144
    ds_read_b128 v[156:159], v10 offset:7168
    s_add_u32 s98, s8, 2
    s_and_b32 s98, s98, 3
    s_lshl_b32 s99, s8, 2
    s_add_u32 s98, s98, s99
    s_lshl_b32 s98, s98, 13
    s_nop 0
    s_add_u32 s98, s98, 9216
    v_add_u32_e64 v10, s98, v2
    ds_read_b128 v[160:163], v10 offset:0
    ds_read_b128 v[164:167], v10 offset:1024
    ds_read_b128 v[168:171], v10 offset:2048
    ds_read_b128 v[172:175], v10 offset:3072
    ds_read_b128 v[176:179], v10 offset:4096
    ds_read_b128 v[180:183], v10 offset:5120
    ds_read_b128 v[184:187], v10 offset:6144
    ds_read_b128 v[188:191], v10 offset:7168
    s_add_u32 s98, s8, 3
    s_and_b32 s98, s98, 3
    s_lshl_b32 s99, s8, 2
    s_add_u32 s98, s98, s99
    s_lshl_b32 s98, s98, 13
    s_nop 0
    s_add_u32 s98, s98, 9216
    v_add_u32_e64 v10, s98, v2
    ds_read_b128 v[192:195], v10 offset:0
    ds_read_b128 v[196:199], v10 offset:1024
    ds_read_b128 v[200:203], v10 offset:2048
    ds_read_b128 v[204:207], v10 offset:3072
    ds_read_b128 v[208:211], v10 offset:4096
    ds_read_b128 v[212:215], v10 offset:5120
    ds_read_b128 v[216:219], v10 offset:6144
    ds_read_b128 v[220:223], v10 offset:7168
    s_waitcnt lgkmcnt(15)
    v_add_f32 v48, v48, v49
    v_add_f32 v50, v50, v51
    v_add_f32 v52, v52, v53
    v_add_f32 v54, v54, v55
    v_add_f32 v56, v56, v57
    v_add_f32 v58, v58, v59
    v_add_f32 v60, v60, v61
    v_add_f32 v62, v62, v63
    v_add_f32 v48, v48, v50
    v_add_f32 v52, v52, v54
    v_add_f32 v56, v56, v58
    v_add_f32_e64 v60, v60, v62
    v_pk_add_f32 v[224:225], v[224:225], v[128:129]
    v_pk_add_f32 v[226:227], v[226:227], v[130:131]
    v_pk_add_f32 v[228:229], v[228:229], v[132:133]
    v_pk_add_f32 v[230:231], v[230:231], v[134:135]
    v_pk_add_f32 v[232:233], v[232:233], v[136:137]
    v_pk_add_f32 v[234:235], v[234:235], v[138:139]
    v_pk_add_f32 v[236:237], v[236:237], v[140:141]
    v_pk_add_f32 v[238:239], v[238:239], v[142:143]
    v_pk_add_f32 v[240:241], v[240:241], v[144:145]
    v_pk_add_f32 v[242:243], v[242:243], v[146:147]
    v_pk_add_f32 v[244:245], v[244:245], v[148:149]
    v_pk_add_f32 v[246:247], v[246:247], v[150:151]
    v_pk_add_f32 v[248:249], v[248:249], v[152:153]
    v_pk_add_f32 v[250:251], v[250:251], v[154:155]
    v_pk_add_f32 v[252:253], v[252:253], v[156:157]
    v_pk_add_f32 v[254:255], v[254:255], v[158:159]
    s_mov_b32 s98, 0x2b800000
    s_mov_b32 s99, 0x56000000
    v_min_f32 v64, v48, v52
    v_min_f32 v65, v56, v60
    v_max_f32 v66, v48, v52
    v_max_f32 v67, v56, v60
    v_add_f32 v68, v48, v52
    v_add_f32 v69, v56, v60
    v_min_f32 v64, v64, v65
    v_max_f32 v66, v66, v67
    v_add_f32 v68, v68, v69
    s_cmp_eq_u32 s8, 1
    s_cselect_b64 s[100:101], -1, 0
    s_nop 0
    v_cndmask_b32_e64 v70, v48, v52, s[100:101]
    s_cmp_eq_u32 s8, 3
    s_cselect_b64 s[100:101], -1, 0
    v_cndmask_b32_e64 v71, v56, v60, s[100:101]
    s_cmp_ge_u32 s8, 2
    s_cselect_b64 s[100:101], -1, 0
    v_cmp_le_f32 vcc, s98, v64
    s_nop 0
    v_cndmask_b32_e64 v48, v70, v71, s[100:101]
    v_cmp_ge_f32 s[100:101], s99, v66
    s_and_b64 vcc, vcc, s[100:101]
    s_nop 0
    v_cmp_o_f32 s[100:101], v68, v68
    s_and_b64 vcc, vcc, s[100:101]
    s_cmp_eq_u64 vcc, -1
    s_cbranch_scc1 L_ok
    s_cmp_eq_u32 s13, 0
    s_cbranch_scc1 L_slow
L_ok:
    v_rcp_f32 v48, v48
    s_waitcnt lgkmcnt(8)
    s_nop 0
    v_pk_add_f32 v[224:225], v[224:225], v[160:161]
    v_pk_add_f32 v[226:227], v[226:227], v[162:163]
    v_pk_add_f32 v[228:229], v[228:229], v[164:165]
    v_pk_add_f32 v[230:231], v[230:231], v[166:167]
    v_pk_add_f32 v[232:233], v[232:233], v[168:169]
    v_pk_add_f32 v[234:235], v[234:235], v[170:171]
    v_pk_add_f32 v[236:237], v[236:237], v[172:173]
    v_pk_add_f32 v[238:239], v[238:239], v[174:175]
    v_pk_add_f32 v[240:241], v[240:241], v[176:177]
    v_pk_add_f32 v[242:243], v[242:243], v[178:179]
    v_pk_add_f32 v[244:245], v[244:245], v[180:181]
    v_pk_add_f32 v[246:247], v[246:247], v[182:183]
    v_pk_add_f32 v[248:249], v[248:249], v[184:185]
    v_pk_add_f32 v[250:251], v[250:251], v[186:187]
    v_pk_add_f32 v[252:253], v[252:253], v[188:189]
    v_pk_add_f32 v[254:255], v[254:255], v[190:191]
    v_mov_b32 v49, v48
    v_lshlrev_b32 v8, 8, v6
    v_lshl_add_u32 v8, v5, 4, v8
    s_lshl_b32 s98, s9, 19
    s_lshl_b32 s99, s10, 14
    s_add_u32 s98, s98, s99
    s_lshl_b32 s99, s8, 12
    s_add_u32 s98, s98, s99
    s_waitcnt lgkmcnt(0)
    v_pk_add_f32 v[224:225], v[224:225], v[192:193]
    v_pk_add_f32 v[226:227], v[226:227], v[194:195]
    v_pk_add_f32 v[228:229], v[228:229], v[196:197]
    v_pk_add_f32 v[230:231], v[230:231], v[198:199]
    v_pk_mul_f32 v[224:225], v[224:225], v[48:49]
    v_pk_mul_f32 v[226:227], v[226:227], v[48:49]
    v_pk_mul_f32 v[228:229], v[228:229], v[48:49]
    v_pk_mul_f32 v[230:231], v[230:231], v[48:49]
    v_cvt_pk_bf16_f32 v64, v224, v228
    v_cvt_pk_bf16_f32 v65, v225, v229
    v_cvt_pk_bf16_f32 v66, v226, v230
    v_cvt_pk_bf16_f32 v67, v227, v231
    buffer_store_dwordx4 v[64:67], v8, s[16:19], s98 offen offset:0 sc1
    v_pk_add_f32 v[232:233], v[232:233], v[200:201]
    v_pk_add_f32 v[234:235], v[234:235], v[202:203]
    v_pk_add_f32 v[236:237], v[236:237], v[204:205]
    v_pk_add_f32 v[238:239], v[238:239], v[206:207]
    v_pk_mul_f32 v[232:233], v[232:233], v[48:49]
    v_pk_mul_f32 v[234:235], v[234:235], v[48:49]
    v_pk_mul_f32 v[236:237], v[236:237], v[48:49]
    v_pk_mul_f32 v[238:239], v[238:239], v[48:49]
    v_cvt_pk_bf16_f32 v68, v232, v236
    v_cvt_pk_bf16_f32 v69, v233, v237
    v_cvt_pk_bf16_f32 v70, v234, v238
    v_cvt_pk_bf16_f32 v71, v235, v239
    buffer_store_dwordx4 v[68:71], v8, s[16:19], s98 offen offset:64 sc1
    v_pk_add_f32 v[240:241], v[240:241], v[208:209]
    v_pk_add_f32 v[242:243], v[242:243], v[210:211]
    v_pk_add_f32 v[244:245], v[244:245], v[212:213]
    v_pk_add_f32 v[246:247], v[246:247], v[214:215]
    v_pk_mul_f32 v[240:241], v[240:241], v[48:49]
    v_pk_mul_f32 v[242:243], v[242:243], v[48:49]
    v_pk_mul_f32 v[244:245], v[244:245], v[48:49]
    v_pk_mul_f32 v[246:247], v[246:247], v[48:49]
    v_cvt_pk_bf16_f32 v72, v240, v244
    v_cvt_pk_bf16_f32 v73, v241, v245
    v_cvt_pk_bf16_f32 v74, v242, v246
    v_cvt_pk_bf16_f32 v75, v243, v247
    buffer_store_dwordx4 v[72:75], v8, s[16:19], s98 offen offset:128 sc1
    v_pk_add_f32 v[248:249], v[248:249], v[216:217]
    v_pk_add_f32 v[250:251], v[250:251], v[218:219]
    v_pk_add_f32 v[252:253], v[252:253], v[220:221]
    v_pk_add_f32 v[254:255], v[254:255], v[222:223]
    v_pk_mul_f32 v[248:249], v[248:249], v[48:49]
    v_pk_mul_f32 v[250:251], v[250:251], v[48:49]
    v_pk_mul_f32 v[252:253], v[252:253], v[48:49]
    v_pk_mul_f32 v[254:255], v[254:255], v[48:49]
    v_cvt_pk_bf16_f32 v76, v248, v252
    v_cvt_pk_bf16_f32 v77, v249, v253
    v_cvt_pk_bf16_f32 v78, v250, v254
    v_cvt_pk_bf16_f32 v79, v251, v255
    buffer_store_dwordx4 v[76:79], v8, s[16:19], s98 offen offset:192 sc1
    s_endpgm
L_slow:
    s_mov_b32 s13, 1
    s_waitcnt vmcnt(0) lgkmcnt(0)
    s_nop 0
    v_mov_b32 v100, 0xff800000
    v_mov_b32 v101, 0xff800000
    v_mov_b32 v102, 0xff800000
    v_mov_b32 v103, 0xff800000
    s_mov_b32 s51, 0
L_maxloop:
    s_and_b32 s98, s51, 7
    s_lshl_b32 s98, s98, 14
    s_lshr_b32 s99, s51, 3
    s_lshl_b32 s99, s99, 19
    s_add_u32 s98, s98, s99
    v_add_u32 v3, s98, v2
    s_add_u32 s51, s51, 1
    global_load_dwordx4 a[64:67], v3, s[44:45] offset:-4096 sc1
    global_load_dwordx4 a[68:71], v3, s[44:45] offset:-3072 sc1
    global_load_dwordx4 a[72:75], v3, s[44:45] offset:-2048 sc1
    global_load_dwordx4 a[76:79], v3, s[44:45] offset:-1024 sc1
    global_load_dwordx4 a[80:83], v3, s[44:45] offset:0 sc1
    global_load_dwordx4 a[84:87], v3, s[44:45] offset:1024 sc1
    global_load_dwordx4 a[88:91], v3, s[44:45] offset:2048 sc1
    global_load_dwordx4 a[92:95], v3, s[44:45] offset:3072 sc1
    s_waitcnt vmcnt(0)
    s_nop 0
    v_mfma_f32_16x16x32_bf16 v[16:19], a[64:67], a[0:3], 0
    v_mfma_f32_16x16x32_bf16 v[16:19], a[68:71], a[4:7], v[16:19]
    v_mfma_f32_16x16x32_bf16 v[16:19], a[72:75], a[8:11], v[16:19]
    v_mfma_f32_16x16x32_bf16 v[16:19], a[76:79], a[12:15], v[16:19]
    v_mfma_f32_16x16x32_bf16 v[20:23], a[80:83], a[0:3], 0
    v_mfma_f32_16x16x32_bf16 v[20:23], a[84:87], a[4:7], v[20:23]
    v_mfma_f32_16x16x32_bf16 v[20:23], a[88:91], a[8:11], v[20:23]
    v_mfma_f32_16x16x32_bf16 v[20:23], a[92:95], a[12:15], v[20:23]
    v_mfma_f32_16x16x32_bf16 v[24:27], a[64:67], a[16:19], 0
    v_mfma_f32_16x16x32_bf16 v[24:27], a[68:71], a[20:23], v[24:27]
    v_mfma_f32_16x16x32_bf16 v[24:27], a[72:75], a[24:27], v[24:27]
    v_mfma_f32_16x16x32_bf16 v[24:27], a[76:79], a[28:31], v[24:27]
    v_mfma_f32_16x16x32_bf16 v[28:31], a[80:83], a[16:19], 0
    v_mfma_f32_16x16x32_bf16 v[28:31], a[84:87], a[20:23], v[28:31]
    v_mfma_f32_16x16x32_bf16 v[28:31], a[88:91], a[24:27], v[28:31]
    v_mfma_f32_16x16x32_bf16 v[28:31], a[92:95], a[28:31], v[28:31]
    v_mfma_f32_16x16x32_bf16 v[32:35], a[64:67], a[32:35], 0
    v_mfma_f32_16x16x32_bf16 v[32:35], a[68:71], a[36:39], v[32:35]
    v_mfma_f32_16x16x32_bf16 v[32:35], a[72:75], a[40:43], v[32:35]
    v_mfma_f32_16x16x32_bf16 v[32:35], a[76:79], a[44:47], v[32:35]
    v_mfma_f32_16x16x32_bf16 v[36:39], a[80:83], a[32:35], 0
    v_mfma_f32_16x16x32_bf16 v[36:39], a[84:87], a[36:39], v[36:39]
    v_mfma_f32_16x16x32_bf16 v[36:39], a[88:91], a[40:43], v[36:39]
    v_mfma_f32_16x16x32_bf16 v[36:39], a[92:95], a[44:47], v[36:39]
    v_mfma_f32_16x16x32_bf16 v[40:43], a[64:67], a[48:51], 0
    v_mfma_f32_16x16x32_bf16 v[40:43], a[68:71], a[52:55], v[40:43]
    v_mfma_f32_16x16x32_bf16 v[40:43], a[72:75], a[56:59], v[40:43]
    v_mfma_f32_16x16x32_bf16 v[40:43], a[76:79], a[60:63], v[40:43]
    v_mfma_f32_16x16x32_bf16 v[44:47], a[80:83], a[48:51], 0
    v_mfma_f32_16x16x32_bf16 v[44:47], a[84:87], a[52:55], v[44:47]
    v_mfma_f32_16x16x32_bf16 v[44:47], a[88:91], a[56:59], v[44:47]
    v_mfma_f32_16x16x32_bf16 v[44:47], a[92:95], a[60:63], v[44:47]
    s_nop 15
    s_nop 0
    v_max3_f32 v100, v100, v16, v17
    v_max3_f32 v100, v100, v18, v19
    v_max3_f32 v100, v100, v20, v21
    v_max3_f32 v100, v100, v22, v23
    v_max3_f32 v101, v101, v24, v25
    v_max3_f32 v101, v101, v26, v27
    v_max3_f32 v101, v101, v28, v29
    v_max3_f32 v101, v101, v30, v31
    v_max3_f32 v102, v102, v32, v33
    v_max3_f32 v102, v102, v34, v35
    v_max3_f32 v102, v102, v36, v37
    v_max3_f32 v102, v102, v38, v39
    v_max3_f32 v103, v103, v40, v41
    v_max3_f32 v103, v103, v42, v43
    v_max3_f32 v103, v103, v44, v45
    v_max3_f32 v103, v103, v46, v47
    s_cmp_lt_u32 s51, 16
    s_cbranch_scc1 L_maxloop
    v_lshrrev_b32 v16, 4, v0
    v_and_b32 v17, 15, v0
    s_lshl_b32 s98, s8, 4
    v_lshlrev_b32 v18, 6, v17
    v_lshl_add_u32 v18, v16, 2, v18
    v_add_u32 v18, s98, v18
    s_add_u32 s98, s8, 1
    s_and_b32 s98, s98, 3
    s_lshl_b32 s98, s98, 10
    s_add_u32 s98, s98, 4096
    v_add_u32_e64 v19, s98, v18
    ds_write_b32 v19, v100
    s_add_u32 s98, s8, 2
    s_and_b32 s98, s98, 3
    s_lshl_b32 s98, s98, 10
    s_nop 0
    s_add_u32 s98, s98, 4096
    v_add_u32_e64 v19, s98, v18
    ds_write_b32 v19, v101
    s_add_u32 s98, s8, 3
    s_and_b32 s98, s98, 3
    s_lshl_b32 s98, s98, 10
    s_nop 0
    s_add_u32 s98, s98, 4096
    v_add_u32_e64 v19, s98, v18
    ds_write_b32 v19, v102
    s_add_u32 s98, s8, 4
    s_and_b32 s98, s98, 3
    s_lshl_b32 s98, s98, 10
    s_nop 0
    s_add_u32 s98, s98, 4096
    v_add_u32_e64 v19, s98, v18
    ds_write_b32 v19, v103
    s_waitcnt lgkmcnt(0)
    s_barrier
    v_lshlrev_b32 v18, 6, v17
    s_add_u32 s98, s8, 1
    s_and_b32 s98, s98, 3
    s_lshl_b32 s98, s98, 10
    s_add_u32 s98, s98, 4096
    v_add_u32_e64 v19, s98, v18
    ds_read_b128 v[24:27], v19 offset:0
    ds_read_b128 v[28:31], v19 offset:16
    ds_read_b128 v[32:35], v19 offset:32
    ds_read_b128 v[36:39], v19 offset:48
    s_waitcnt lgkmcnt(0)
    s_nop 0
    v_max3_f32 v100, v24, v25, v26
    v_max3_f32 v100, v100, v27, v28
    v_max3_f32 v100, v100, v29, v30
    v_max3_f32 v100, v100, v31, v32
    v_max3_f32 v100, v100, v33, v34
    v_max3_f32 v100, v100, v35, v36
    v_max3_f32 v100, v100, v37, v38
    v_max_f32 v100, v100, v39
    s_add_u32 s98, s8, 2
    s_and_b32 s98, s98, 3
    s_lshl_b32 s98, s98, 10
    s_add_u32 s98, s98, 4096
    v_add_u32_e64 v19, s98, v18
    ds_read_b128 v[24:27], v19 offset:0
    ds_read_b128 v[28:31], v19 offset:16
    ds_read_b128 v[32:35], v19 offset:32
    ds_read_b128 v[36:39], v19 offset:48
    s_waitcnt lgkmcnt(0)
    s_nop 0
    v_max3_f32 v101, v24, v25, v26
    v_max3_f32 v101, v101, v27, v28
    v_max3_f32 v101, v101, v29, v30
    v_max3_f32 v101, v101, v31, v32
    v_max3_f32 v101, v101, v33, v34
    v_max3_f32 v101, v101, v35, v36
    v_max3_f32 v101, v101, v37, v38
    v_max_f32 v101, v101, v39
    s_add_u32 s98, s8, 3
    s_and_b32 s98, s98, 3
    s_lshl_b32 s98, s98, 10
    s_add_u32 s98, s98, 4096
    v_add_u32_e64 v19, s98, v18
    ds_read_b128 v[24:27], v19 offset:0
    ds_read_b128 v[28:31], v19 offset:16
    ds_read_b128 v[32:35], v19 offset:32
    ds_read_b128 v[36:39], v19 offset:48
    s_waitcnt lgkmcnt(0)
    s_nop 0
    v_max3_f32 v102, v24, v25, v26
    v_max3_f32 v102, v102, v27, v28
    v_max3_f32 v102, v102, v29, v30
    v_max3_f32 v102, v102, v31, v32
    v_max3_f32 v102, v102, v33, v34
    v_max3_f32 v102, v102, v35, v36
    v_max3_f32 v102, v102, v37, v38
    v_max_f32 v102, v102, v39
    s_add_u32 s98, s8, 4
    s_and_b32 s98, s98, 3
    s_lshl_b32 s98, s98, 10
    s_add_u32 s98, s98, 4096
    v_add_u32_e64 v19, s98, v18
    ds_read_b128 v[24:27], v19 offset:0
    ds_read_b128 v[28:31], v19 offset:16
    ds_read_b128 v[32:35], v19 offset:32
    ds_read_b128 v[36:39], v19 offset:48
    s_waitcnt lgkmcnt(0)
    s_nop 0
    v_max3_f32 v103, v24, v25, v26
    v_max3_f32 v103, v103, v27, v28
    v_max3_f32 v103, v103, v29, v30
    v_max3_f32 v103, v103, v31, v32
    v_max3_f32 v103, v103, v33, v34
    v_max3_f32 v103, v103, v35, v36
    v_max3_f32 v103, v103, v37, v38
    v_max_f32 v103, v103, v39
    v_sub_f32 v64, 0, v100
    v_sub_f32 v65, 0, v100
    v_sub_f32 v66, 0, v100
    v_sub_f32 v67, 0, v100
    v_sub_f32 v68, 0, v101
    v_sub_f32 v69, 0, v101
    v_sub_f32 v70, 0, v101
    v_sub_f32 v71, 0, v101
    v_sub_f32 v72, 0, v102
    v_sub_f32 v73, 0, v102
    v_sub_f32 v74, 0, v102
    v_sub_f32 v75, 0, v102
    v_sub_f32 v76, 0, v103
    v_sub_f32 v77, 0, v103
    v_sub_f32 v78, 0, v103
    v_sub_f32 v79, 0, v103
    v_lshrrev_b32 v5, 4, v0
    v_and_b32 v6, 15, v0
    v_lshlrev_b32 v8, 8, v5
    v_lshl_add_u32 v8, v6, 3, v8
    v_and_b32 v9, 1, v6
    v_lshlrev_b32 v9, 13, v9
    v_lshl_add_u32 v9, v5, 2, v9
    v_lshlrev_b32_e64 v10, 9, v5
    v_lshl_add_u32 v10, v6, 4, v10
    v_lshlrev_b32_e64 v11, 8, v6
    v_lshl_add_u32 v11, v5, 4, v11
    v_lshlrev_b32_e64 v12, 11, v5
    v_lshl_add_u32 v12, v6, 3, v12
    v_lshlrev_b32 v13, 4, v5
    s_barrier
    s_branch L_run
L_done:
    s_endpgm
.section .rodata,"a"
.p2align 6
.amdhsa_kernel standalone__kv_cache_quant_pre_rope_vs_post_rope__prompt_kernel
  .amdhsa_next_free_vgpr 512
  .amdhsa_next_free_sgpr 102
  .amdhsa_accum_offset 256
  .amdhsa_group_segment_fixed_size 0
  .amdhsa_kernarg_size 112
  .amdhsa_user_sgpr_count 2
  .amdhsa_user_sgpr_kernarg_segment_ptr 1
  .amdhsa_system_sgpr_workgroup_id_x 1
.end_amdhsa_kernel
.text
```
